```python
import torch

def _softmax(x, axis=-1):
    return torch.softmax(x, dim=axis)
def _gelu(x):
    return torch.nn.functional.gelu(x, approximate="tanh")
def _silu(x):
    return torch.nn.functional.silu(x)
def _sigmoid(x):
    return torch.sigmoid(x)
def _layernorm(x, axis=-1, eps=1e-5):
    m = x.mean(dim=axis, keepdim=True)
    v = x.var(dim=axis, keepdim=True, unbiased=False)
    return (x - m) / torch.sqrt(v + eps)
def _scatter_add(tgt, idx, src, axis=0):
    return tgt.clone().index_add_(axis, idx, src)
def _segment_sum(src, seg, n):
    out = torch.zeros((n,) + src.shape[1:], dtype=src.dtype)
    return out.index_add_(0, seg, src)
def _pad(x, pw):
    flat = tuple(v for pair in reversed(pw) for v in pair)
    return torch.nn.functional.pad(x, flat)

kernel_name = 'sequential_preLN__sliding_block_cached__dense_activation_silu__decode'

def setup_inputs():

    _w = (lambda a: (lambda t: t.to(torch.bfloat16) if t.is_floating_point() else t)(torch.as_tensor(a)))
    def _A_setup():
        B, Sq, D = 2, 1, 512
        Hq, Hkv, Sk, Dh = 32, 8, 8192, 128
        assert Hq % Hkv == 0, (Hq, Hkv)
        return {
            "x": _w((lambda *s: torch.randn(*s, dtype=torch.bfloat16) * 0.05)(B, Sq, D)),
            "k_cache": _w((lambda *s: torch.randn(*s, dtype=torch.bfloat16) * 3.2)(B, Hkv, Sk, Dh)),
            "v_cache": _w((lambda *s: torch.randn(*s, dtype=torch.bfloat16) * 0.8)(B, Hkv, Sk, Dh)),
            "wq": _w((lambda *s: torch.randn(*s, dtype=torch.bfloat16) * 3.2)(D, Hq * Dh) * (D ** -0.5)),
            "wo": _w((lambda *s: torch.randn(*s, dtype=torch.bfloat16) * 0.8)(Hq * Dh, D) * ((Hq * Dh) ** -0.5)),
        }
    _A_in = _A_setup()

    def _B_setup():
        B, S, D, F = 2, 1, 512, 1792
        return {
            "x": _w((lambda *s: torch.randn(*s, dtype=torch.bfloat16) * 0.05)(B, S, D)),
            "w1": _w((lambda *s: torch.randn(*s, dtype=torch.bfloat16) * 3.2)(D, F) * (D ** -0.5)),
            "w2": _w((lambda *s: torch.randn(*s, dtype=torch.bfloat16) * 0.4)(F, D) * (F ** -0.5)),
        }
    _B_in = _B_setup()

    return {
        "A_x": _A_in["x"],
        "A_k_cache": _A_in["k_cache"],
        "A_v_cache": _A_in["v_cache"],
        "A_wq": _A_in["wq"],
        "A_wo": _A_in["wo"],
        "B_x": _B_in["x"],
        "B_w1": _B_in["w1"],
        "B_w2": _B_in["w2"],
    }

def reference(A_x, A_k_cache, A_v_cache, A_wq, A_wo, B_x, B_w1, B_w2):
    def _A_ref(x, k_cache, v_cache, wq, wo):
        B, Sq, D = x.shape
        Hq, Dh = 32, 128
        Hkv, Sk = k_cache.shape[1], k_cache.shape[2]
        W = min(4096, max(256, Sk // 4))
        rep = Hq // Hkv
        q = (lambda x, *d: x.permute(*d))((x @ wq).reshape(B, Sq, Hq, Dh), 0, 2, 1, 3)
        k = (lambda x, n, axis: torch.repeat_interleave(x, n, dim=axis))(k_cache[:, :, Sk - W:, :], rep, axis=1)
        v = (lambda x, n, axis: torch.repeat_interleave(x, n, dim=axis))(v_cache[:, :, Sk - W:, :], rep, axis=1)
        scores = torch.einsum("bhqd,bhkd->bhqk", q, k) * (Dh ** -0.5)
        p = _softmax(scores, axis=-1)
        o = torch.einsum("bhqk,bhkd->bhqd", p, v)
        return (lambda x, *d: x.permute(*d))(o, 0, 2, 1, 3).reshape(B, Sq, Hq * Dh) @ wo

    def _B_ref(x, w1, w2):
        h = torch.einsum("bsd,df->bsf", x, w1)
        h = _silu(h)
        out = torch.einsum("bsf,fd->bsd", h, w2)
        return out

    x = A_x
    h = x + _A_ref(_layernorm(x, axis=-1), A_k_cache, A_v_cache, A_wq, A_wo)
    h2 = h + _B_ref(_layernorm(h, axis=-1), B_w1, B_w2)
    return h2
```

```asm
; @launch grid=(256,1,1) block=(512,1,1) lds=67584
.amdgcn_target "amdgcn-amd-amdhsa--gfx950"
.text
.globl sequential_preLN__sliding_block_cached__dense_activation_silu__decode_kernel
.p2align 8
.type sequential_preLN__sliding_block_cached__dense_activation_silu__decode_kernel,@function
sequential_preLN__sliding_block_cached__dense_activation_silu__decode_kernel:
    s_cmp_ge_u32 s2, 256
    s_cbranch_scc1 L_end
    s_load_dwordx16 s[16:31], s[0:1], 0
    s_load_dwordx4 s[32:35], s[0:1], 64
    s_load_dwordx2 s[36:37], s[0:1], 80
    v_lshrrev_b32 v1, 6, v0
    v_and_b32 v0, 63, v0
    v_lshrrev_b32 v3, 4, v0
    v_readfirstlane_b32 s3, v1
    s_and_b32 s4, s2, 7
    s_lshr_b32 s5, s2, 4
    v_lshlrev_b32 v7, 4, v0
    s_bitcmp1_b32 s2, 3
    s_cbranch_scc0 L_att
    s_lshl_b32 s14, s4, 4
    s_add_u32 s14, s14, s5
    s_cmp_ge_u32 s3, 4
    s_cbranch_scc1 L_t_aux
    v_lshrrev_b32 v2, 3, v0
    v_lshlrev_b32 v2, 16, v2
    v_and_b32 v4, 7, v0
    v_lshl_add_u32 v6, v4, 4, v2
    s_lshr_b32 s10, s5, 3
    s_and_b32 s11, s5, 7
    s_lshl_b32 s8, s4, 10
    s_lshl_b32 s9, s11, 7
    s_add_u32 s8, s8, s9
    s_lshl_b32 s9, s10, 2
    s_add_u32 s9, s9, s3
    s_lshl_b32 s9, s9, 19
    s_add_u32 s8, s8, s9
    s_waitcnt lgkmcnt(0)
    s_mov_b32 s48, s22
    s_and_b32 s49, s23, 0xffff
    s_mov_b32 s50, 4194304
    s_mov_b32 s51, 0x20000
    s_barrier
    buffer_load_dwordx4 v[24:27], v6, s[48:51], s8 offen nt
    s_add_u32 s8, s8, 8192
    buffer_load_dwordx4 v[28:31], v6, s[48:51], s8 offen nt
    s_add_u32 s8, s8, 8192
    buffer_load_dwordx4 v[32:35], v6, s[48:51], s8 offen nt
    s_add_u32 s8, s8, 8192
    buffer_load_dwordx4 v[36:39], v6, s[48:51], s8 offen nt
    s_add_u32 s8, s8, 8192
    buffer_load_dwordx4 v[40:43], v6, s[48:51], s8 offen nt
    s_add_u32 s8, s8, 8192
    buffer_load_dwordx4 v[44:47], v6, s[48:51], s8 offen nt
    s_add_u32 s8, s8, 8192
    buffer_load_dwordx4 v[48:51], v6, s[48:51], s8 offen nt
    s_add_u32 s8, s8, 8192
    buffer_load_dwordx4 v[52:55], v6, s[48:51], s8 offen nt
    s_branch L_tail1
L_t_aux:
    v_mov_b32 v124, -1
    v_mov_b32 v125, -1
    v_mov_b32 v126, -1
    v_mov_b32 v127, -1
    s_waitcnt lgkmcnt(0)
    s_mov_b32 s40, s36
    s_and_b32 s41, s37, 0xffff
    s_mov_b32 s42, 1048576
    s_mov_b32 s43, 0x20000
    s_mov_b32 s44, s16
    s_and_b32 s45, s17, 0xffff
    s_mov_b32 s46, 2048
    s_mov_b32 s47, 0x20000
    s_cmp_eq_u32 s3, 4
    s_cbranch_scc1 L_t_x
    s_cmp_eq_u32 s3, 5
    s_cbranch_scc1 L_t_co
    s_cmp_eq_u32 s3, 6
    s_cbranch_scc1 L_t_ca
    s_cmp_lg_u32 s5, 0
    s_cbranch_scc1 L_t_auxb
    s_lshl_b32 s6, s4, 13
    s_add_u32 s7, s6, 4096
    buffer_store_dwordx4 v[124:127], v7, s[40:43], s6 offen sc1
    buffer_store_dwordx4 v[124:127], v7, s[40:43], s6 offen offset:1024 sc1
    buffer_store_dwordx4 v[124:127], v7, s[40:43], s6 offen offset:2048 sc1
    buffer_store_dwordx4 v[124:127], v7, s[40:43], s6 offen offset:3072 sc1
    buffer_store_dwordx4 v[124:127], v7, s[40:43], s7 offen sc1
    buffer_store_dwordx4 v[124:127], v7, s[40:43], s7 offen offset:1024 sc1
    buffer_store_dwordx4 v[124:127], v7, s[40:43], s7 offen offset:2048 sc1
    buffer_store_dwordx4 v[124:127], v7, s[40:43], s7 offen offset:3072 sc1
    s_branch L_t_auxb
L_t_x:
    buffer_load_dwordx4 v[8:11], v7, s[44:47], 0 offen
    buffer_load_dwordx4 v[12:15], v7, s[44:47], 0 offen offset:1024
    s_branch L_t_auxb
L_t_co:
    s_lshl_b32 s9, s14, 11
    s_add_u32 s9, s9, 65536
    buffer_store_dwordx4 v[124:127], v7, s[40:43], s9 offen sc1
    buffer_store_dwordx4 v[124:127], v7, s[40:43], s9 offen offset:1024 sc1
    s_branch L_t_auxb
L_t_ca:
    s_cmp_ge_u32 s5, 8
    s_cbranch_scc1 L_t_auxb
    s_lshl_b32 s10, s4, 3
    s_add_u32 s10, s10, s5
    s_lshl_b32 s10, s10, 9
    s_add_u32 s10, s10, 393216
    s_mov_b32 exec_hi, 0
    buffer_store_dwordx4 v[124:127], v7, s[40:43], s10 offen sc1
    s_mov_b64 exec, -1
L_t_auxb:
    s_barrier
    s_branch L_tail1
L_att:
    v_and_b32 v2, 15, v0
    v_xor_b32 v4, v2, v3
    v_lshlrev_b32 v4, 4, v4
    v_xor_b32 v116, 0, v4
    v_lshl_add_u32 v112, v3, 8, v116
    v_xor_b32 v117, 64, v4
    v_lshl_add_u32 v113, v3, 8, v117
    v_xor_b32 v118, 128, v4
    v_lshl_add_u32 v114, v3, 8, v118
    v_xor_b32 v119, 192, v4
    v_lshl_add_u32 v115, v3, 8, v119
    v_lshlrev_b32 v4, 10, v3
    v_lshl_add_u32 v5, v2, 4, v4
    s_lshr_b32 s6, s5, 3
    s_and_b32 s7, s5, 7
    s_lshl_b32 s8, s6, 3
    s_add_u32 s8, s8, s4
    s_lshl_b32 s8, s8, 13
    s_lshl_b32 s9, s7, 8
    s_add_u32 s8, s8, s9
    s_lshl_b32 s9, s3, 5
    s_add_u32 s8, s8, s9
    s_add_u32 s8, s8, 6144
    s_lshl_b32 s8, s8, 8
    s_add_u32 s9, s8, 4096
    s_lshl_b32 s13, s3, 13
    s_add_u32 s13, s13, 2048
    s_add_u32 s12, s13, 4096
    s_mov_b32 m0, s13
    s_waitcnt lgkmcnt(0)
    s_mov_b32 s44, s18
    s_and_b32 s45, s19, 0xffff
    s_mov_b32 s46, 33554432
    s_mov_b32 s47, 0x20000
    buffer_load_dwordx4 v112, s[44:47], s8 offen offset:0 nt lds
    buffer_load_dwordx4 v113, s[44:47], s8 offen offset:1024 nt lds
    buffer_load_dwordx4 v114, s[44:47], s8 offen offset:2048 nt lds
    buffer_load_dwordx4 v115, s[44:47], s8 offen offset:3072 nt lds
    s_mov_b32 m0, s12
    s_nop 0
    buffer_load_dwordx4 v112, s[44:47], s9 offen offset:0 nt lds
    buffer_load_dwordx4 v113, s[44:47], s9 offen offset:1024 nt lds
    buffer_load_dwordx4 v114, s[44:47], s9 offen offset:2048 nt lds
    buffer_load_dwordx4 v115, s[44:47], s9 offen offset:3072 nt lds
    s_mov_b32 s48, s20
    s_and_b32 s49, s21, 0xffff
    s_mov_b32 s50, 33554432
    s_mov_b32 s51, 0x20000
    s_barrier
    s_mov_b32 s52, s34
    s_and_b32 s53, s35, 0xffff
    s_mov_b32 s54, 256
    s_mov_b32 s55, 0x20000
    s_lshl_b32 s6, s4, 2
    v_mov_b32 v124, s6
    s_cmp_lg_u32 s3, 0
    s_cbranch_scc1 L_a_nfs
    s_mov_b64 exec, 1
    buffer_load_dword v125, v124, s[52:55], 0 offen offset:128 sc1
    s_mov_b64 exec, -1
L_a_nfs:
    buffer_load_dwordx4 v[48:51], v5, s[48:51], s8 offen nt
    buffer_load_dwordx4 v[52:55], v5, s[48:51], s8 offen offset:256 nt
    buffer_load_dwordx4 v[56:59], v5, s[48:51], s8 offen offset:512 nt
    buffer_load_dwordx4 v[60:63], v5, s[48:51], s8 offen offset:768 nt
    buffer_load_dwordx4 v[64:67], v5, s[48:51], s9 offen nt
    buffer_load_dwordx4 v[68:71], v5, s[48:51], s9 offen offset:256 nt
    s_branch L_att1
L_tail1:
    s_mov_b32 s60, 0x05040100
    s_mov_b32 s61, 0x07060302
    s_mov_b32 s40, s36
    s_and_b32 s41, s37, 0xffff
    s_mov_b32 s42, 1048576
    s_mov_b32 s43, 0x20000
    s_mov_b32 s44, s16
    s_and_b32 s45, s17, 0xffff
    s_mov_b32 s46, 2048
    s_mov_b32 s47, 0x20000
    s_mov_b32 s52, s34
    s_and_b32 s53, s35, 0xffff
    s_mov_b32 s54, 256
    s_mov_b32 s55, 0x20000
    s_lshl_b32 s6, s4, 2
    v_mov_b32 v123, s6
    s_cmp_lt_u32 s3, 4
    s_cbranch_scc1 L_t_main
    s_waitcnt vmcnt(0)
    s_cmp_lg_u32 s3, 4
    s_cbranch_scc1 L_t_a1
    ds_write_b128 v7, v[8:11] offset:2048
    ds_write_b128 v7, v[12:15] offset:3072
    s_waitcnt lgkmcnt(0)
    s_barrier
    s_barrier
    s_branch L_t_np
L_t_a1:
    s_lshl_b32 s6, s5, 3
    s_add_u32 s6, s6, s3
    s_cmp_lg_u32 s6, 7
    s_cbranch_scc1 L_t_a2
    v_mov_b32 v4, 1
    s_mov_b64 exec, 1
    buffer_store_dword v4, v123, s[52:55], 0 offen offset:128 sc1
    s_mov_b64 exec, -1
L_t_a2:
    s_barrier
    s_barrier
    s_branch L_t_np
L_t_main:
    v_lshrrev_b32 v2, 2, v0
    v_and_b32 v5, 1, v0
    v_lshl_add_u32 v2, v2, 1, v5
    v_lshlrev_b32 v2, 4, v2
    v_and_b32 v6, 2, v0
    v_lshl_add_u32 v20, v6, 9, v2
    v_lshl_add_u32 v2, v3, 1, v5
    s_lshl_b32 s6, s10, 2
    s_add_u32 s6, s6, s3
    s_lshl_b32 s6, s6, 7
    v_lshl_add_u32 v21, v2, 4, s6
    v_lshl_add_u32 v21, v6, 9, v21
    v_lshl_add_u32 v2, v3, 3, v4
    s_lshl_b32 s7, s3, 9
    v_lshl_add_u32 v22, v2, 4, s7
    v_and_b32 v2, 31, v0
    v_lshlrev_b32 v2, 4, v2
    v_and_b32 v5, 32, v0
    v_lshl_add_u32 v23, v5, 5, v2
    v_lshrrev_b32 v2, 2, v0
    v_and_b32 v2, 3, v2
    v_cmp_eq_u32_e64 s[80:81], 0, v2
    v_cmp_eq_u32_e64 s[82:83], 1, v2
    v_cmp_eq_u32_e64 s[84:85], 2, v2
    v_cmp_eq_u32_e64 s[86:87], 3, v2
    v_and_b32 v2, 8, v0
    v_cmp_ne_u32_e64 s[12:13], 0, v2
    s_lshl_b32 s8, s14, 9
    v_lshlrev_b32 v6, 3, v0
    s_barrier
    ds_read_b128 v[8:11], v20 offset:2048
    ds_read_b128 v[12:15], v20 offset:2560
    ds_read_b128 v[16:19], v21 offset:2048
    s_waitcnt lgkmcnt(0)
    s_mov_b32 s6, 0x3f803f80
    v_dot2_f32_bf16 v104, v8, s6, 0
    v_dot2_f32_bf16 v106, v8, v8, 0
    v_dot2_f32_bf16 v105, v9, s6, 0
    v_dot2_f32_bf16 v107, v9, v9, 0
    v_dot2_f32_bf16 v104, v10, s6, v104
    v_dot2_f32_bf16 v106, v10, v10, v106
    v_dot2_f32_bf16 v105, v11, s6, v105
    v_dot2_f32_bf16 v107, v11, v11, v107
    v_dot2_f32_bf16 v104, v12, s6, v104
    v_dot2_f32_bf16 v106, v12, v12, v106
    v_dot2_f32_bf16 v105, v13, s6, v105
    v_dot2_f32_bf16 v107, v13, v13, v107
    v_dot2_f32_bf16 v104, v14, s6, v104
    v_dot2_f32_bf16 v106, v14, v14, v106
    v_dot2_f32_bf16 v105, v15, s6, v105
    v_dot2_f32_bf16 v107, v15, v15, v107
    s_nop 2
    v_add_f32 v104, v104, v105
    v_add_f32 v106, v106, v107
    s_nop 0
    v_add_f32_dpp v104, v104, v104 quad_perm:[1,0,3,2] row_mask:0xf bank_mask:0xf
    v_add_f32_dpp v106, v106, v106 quad_perm:[1,0,3,2] row_mask:0xf bank_mask:0xf
    s_nop 0
    v_add_f32_dpp v104, v104, v104 row_ror:4 row_mask:0xf bank_mask:0xf
    v_add_f32_dpp v106, v106, v106 row_ror:4 row_mask:0xf bank_mask:0xf
    s_nop 0
    v_add_f32_dpp v104, v104, v104 row_ror:8 row_mask:0xf bank_mask:0xf
    v_add_f32_dpp v106, v106, v106 row_ror:8 row_mask:0xf bank_mask:0xf
    v_mov_b32 v110, v104
    v_mov_b32 v111, v106
    s_nop 0
    v_permlane16_swap_b32 v104, v110
    v_permlane16_swap_b32 v106, v111
    v_add_f32 v104, v104, v110
    v_add_f32 v106, v106, v111
    v_mov_b32 v110, v104
    v_mov_b32 v111, v106
    s_nop 0
    v_permlane32_swap_b32 v104, v110
    v_permlane32_swap_b32 v106, v111
    v_add_f32 v104, v104, v110
    v_add_f32 v106, v106, v111
    v_mul_f32 v108, 0xbb000000, v104
    v_mul_f32 v110, v108, v104
    v_add_f32 v106, v106, v110
    v_cmp_nle_f32_e64 vcc, -v110, v106
    s_cbranch_vccz L_lnjoin_2
    v_lshlrev_b32 v88, 16, v8
    v_and_b32 v89, 0xffff0000, v8
    v_lshlrev_b32 v90, 16, v9
    v_and_b32 v91, 0xffff0000, v9
    v_lshlrev_b32 v92, 16, v10
    v_and_b32 v93, 0xffff0000, v10
    v_lshlrev_b32 v94, 16, v11
    v_and_b32 v95, 0xffff0000, v11
    v_lshlrev_b32 v96, 16, v12
    v_and_b32 v97, 0xffff0000, v12
    v_lshlrev_b32 v98, 16, v13
    v_and_b32 v99, 0xffff0000, v13
    v_lshlrev_b32 v100, 16, v14
    v_and_b32 v101, 0xffff0000, v14
    v_lshlrev_b32 v102, 16, v15
    v_and_b32 v103, 0xffff0000, v15
    v_pk_add_f32 v[104:105], v[88:89], v[90:91]
    v_pk_add_f32 v[106:107], v[92:93], v[94:95]
    v_pk_add_f32 v[104:105], v[104:105], v[96:97]
    v_pk_add_f32 v[106:107], v[106:107], v[98:99]
    v_pk_add_f32 v[104:105], v[104:105], v[100:101]
    v_pk_add_f32 v[106:107], v[106:107], v[102:103]
    v_pk_add_f32 v[104:105], v[104:105], v[106:107]
    v_add_f32 v104, v104, v105
    s_nop 1
    v_add_f32_dpp v104, v104, v104 quad_perm:[1,0,3,2] row_mask:0xf bank_mask:0xf
    s_nop 1
    v_add_f32_dpp v104, v104, v104 row_ror:4 row_mask:0xf bank_mask:0xf
    s_nop 1
    v_add_f32_dpp v104, v104, v104 row_ror:8 row_mask:0xf bank_mask:0xf
    v_mov_b32 v110, v104
    s_nop 0
    s_nop 0
    v_permlane16_swap_b32 v104, v110
    v_add_f32 v104, v104, v110
    v_mov_b32 v110, v104
    s_nop 0
    s_nop 0
    v_permlane32_swap_b32 v104, v110
    v_add_f32 v104, v104, v110
    v_mul_f32 v108, 0xbb000000, v104
    v_pk_add_f32 v[88:89], v[108:109], v[88:89] op_sel_hi:[0,1]
    v_pk_add_f32 v[90:91], v[108:109], v[90:91] op_sel_hi:[0,1]
    v_pk_add_f32 v[92:93], v[108:109], v[92:93] op_sel_hi:[0,1]
    v_pk_add_f32 v[94:95], v[108:109], v[94:95] op_sel_hi:[0,1]
    v_pk_add_f32 v[96:97], v[108:109], v[96:97] op_sel_hi:[0,1]
    v_pk_add_f32 v[98:99], v[108:109], v[98:99] op_sel_hi:[0,1]
    v_pk_add_f32 v[100:101], v[108:109], v[100:101] op_sel_hi:[0,1]
    v_pk_add_f32 v[102:103], v[108:109], v[102:103] op_sel_hi:[0,1]
    v_pk_mul_f32 v[106:107], v[88:89], v[88:89]
    v_pk_mul_f32 v[104:105], v[90:91], v[90:91]
    v_pk_fma_f32 v[106:107], v[92:93], v[92:93], v[106:107]
    v_pk_fma_f32 v[104:105], v[94:95], v[94:95], v[104:105]
    v_pk_fma_f32 v[106:107], v[96:97], v[96:97], v[106:107]
    v_pk_fma_f32 v[104:105], v[98:99], v[98:99], v[104:105]
    v_pk_fma_f32 v[106:107], v[100:101], v[100:101], v[106:107]
    v_pk_fma_f32 v[104:105], v[102:103], v[102:103], v[104:105]
    v_pk_add_f32 v[106:107], v[106:107], v[104:105]
    v_add_f32 v106, v106, v107
    s_nop 1
    v_add_f32_dpp v106, v106, v106 quad_perm:[1,0,3,2] row_mask:0xf bank_mask:0xf
    s_nop 1
    v_add_f32_dpp v106, v106, v106 row_ror:4 row_mask:0xf bank_mask:0xf
    s_nop 1
    v_add_f32_dpp v106, v106, v106 row_ror:8 row_mask:0xf bank_mask:0xf
    v_mov_b32 v110, v106
    s_nop 0
    s_nop 0
    v_permlane16_swap_b32 v106, v110
    v_add_f32 v106, v106, v110
    v_mov_b32 v110, v106
    s_nop 0
    s_nop 0
    v_permlane32_swap_b32 v106, v110
    v_add_f32 v106, v106, v110
L_lnjoin_2:
    s_nop 3
    v_cvt_pk_bf16_f32 v112, v108, v108
    v_lshlrev_b32 v112, 16, v112
    v_lshlrev_b32 v88, 16, v16
    v_and_b32 v89, 0xffff0000, v16
    v_lshlrev_b32 v90, 16, v17
    v_and_b32 v91, 0xffff0000, v17
    v_lshlrev_b32 v92, 16, v18
    v_and_b32 v93, 0xffff0000, v18
    v_lshlrev_b32 v94, 16, v19
    v_and_b32 v95, 0xffff0000, v19
    v_mul_f32 v106, 0x3b000000, v106
    v_cvt_pk_bf16_f32 v106, v106, v106
    v_lshlrev_b32 v106, 16, v106
    v_add_f32 v106, 0x3727c5ac, v106
    v_cvt_pk_bf16_f32 v106, v106, v106
    v_lshlrev_b32 v106, 16, v106
    v_sqrt_f32 v106, v106
    v_pk_add_f32 v[88:89], v[112:113], v[88:89] op_sel_hi:[0,1]
    v_pk_add_f32 v[90:91], v[112:113], v[90:91] op_sel_hi:[0,1]
    v_pk_add_f32 v[92:93], v[112:113], v[92:93] op_sel_hi:[0,1]
    v_pk_add_f32 v[94:95], v[112:113], v[94:95] op_sel_hi:[0,1]
    v_cvt_pk_bf16_f32 v106, v106, v106
    v_lshlrev_b32 v106, 16, v106
    v_rcp_f32 v110, v106
    v_cvt_pk_bf16_f32 v16, v88, v89
    v_cvt_pk_bf16_f32 v17, v90, v91
    v_cvt_pk_bf16_f32 v18, v92, v93
    v_cvt_pk_bf16_f32 v19, v94, v95
    v_lshlrev_b32 v88, 16, v16
    v_and_b32 v89, 0xffff0000, v16
    v_lshlrev_b32 v90, 16, v17
    v_and_b32 v91, 0xffff0000, v17
    v_lshlrev_b32 v92, 16, v18
    v_and_b32 v93, 0xffff0000, v18
    v_lshlrev_b32 v94, 16, v19
    v_and_b32 v95, 0xffff0000, v19
    v_pk_mul_f32 v[88:89], v[110:111], v[88:89] op_sel_hi:[0,1]
    v_pk_mul_f32 v[90:91], v[110:111], v[90:91] op_sel_hi:[0,1]
    v_pk_mul_f32 v[92:93], v[110:111], v[92:93] op_sel_hi:[0,1]
    v_pk_mul_f32 v[94:95], v[110:111], v[94:95] op_sel_hi:[0,1]
    v_cvt_pk_bf16_f32 v16, v88, v89
    v_cvt_pk_bf16_f32 v17, v90, v91
    v_cvt_pk_bf16_f32 v18, v92, v93
    v_cvt_pk_bf16_f32 v19, v94, v95
    v_cndmask_b32_e64 v88, 0, v16, s[80:81]
    v_cndmask_b32_e64 v89, 0, v17, s[80:81]
    v_cndmask_b32_e64 v90, 0, v18, s[80:81]
    v_cndmask_b32_e64 v91, 0, v19, s[80:81]
    v_cndmask_b32_e64 v92, 0, v16, s[82:83]
    v_cndmask_b32_e64 v93, 0, v17, s[82:83]
    v_cndmask_b32_e64 v94, 0, v18, s[82:83]
    v_cndmask_b32_e64 v95, 0, v19, s[82:83]
    v_cndmask_b32_e64 v96, 0, v16, s[84:85]
    v_cndmask_b32_e64 v97, 0, v17, s[84:85]
    v_cndmask_b32_e64 v98, 0, v18, s[84:85]
    v_cndmask_b32_e64 v99, 0, v19, s[84:85]
    v_cndmask_b32_e64 v100, 0, v16, s[86:87]
    v_cndmask_b32_e64 v101, 0, v17, s[86:87]
    v_cndmask_b32_e64 v102, 0, v18, s[86:87]
    v_cndmask_b32_e64 v103, 0, v19, s[86:87]
    s_waitcnt vmcnt(4)
    s_cmp_lg_u32 s3, 0
    s_cbranch_scc1 L_t_nfs
    s_mov_b64 exec, 1
    buffer_load_dword v5, v123, s[52:55], 0 offen offset:128 sc1
    s_mov_b64 exec, -1
    v_perm_b32 v56, v28, v24, s60
    v_perm_b32 v60, v28, v24, s61
    v_perm_b32 v64, v29, v25, s60
    v_perm_b32 v68, v29, v25, s61
    v_perm_b32 v72, v30, v26, s60
    v_perm_b32 v76, v30, v26, s61
    v_perm_b32 v80, v31, v27, s60
    v_perm_b32 v84, v31, v27, s61
    v_perm_b32 v57, v36, v32, s60
    v_perm_b32 v61, v36, v32, s61
    v_perm_b32 v65, v37, v33, s60
    v_perm_b32 v69, v37, v33, s61
    v_perm_b32 v73, v38, v34, s60
    v_perm_b32 v77, v38, v34, s61
    v_perm_b32 v81, v39, v35, s60
    v_perm_b32 v85, v39, v35, s61
    s_waitcnt vmcnt(1)
    s_branch L_t_nfs2
L_t_nfs:
    v_perm_b32 v56, v28, v24, s60
    v_perm_b32 v60, v28, v24, s61
    v_perm_b32 v64, v29, v25, s60
    v_perm_b32 v68, v29, v25, s61
    v_perm_b32 v72, v30, v26, s60
    v_perm_b32 v76, v30, v26, s61
    v_perm_b32 v80, v31, v27, s60
    v_perm_b32 v84, v31, v27, s61
    v_perm_b32 v57, v36, v32, s60
    v_perm_b32 v61, v36, v32, s61
    v_perm_b32 v65, v37, v33, s60
    v_perm_b32 v69, v37, v33, s61
    v_perm_b32 v73, v38, v34, s60
    v_perm_b32 v77, v38, v34, s61
    v_perm_b32 v81, v39, v35, s60
    v_perm_b32 v85, v39, v35, s61
    s_waitcnt vmcnt(0)
L_t_nfs2:
    v_perm_b32 v58, v44, v40, s60
    v_perm_b32 v62, v44, v40, s61
    v_perm_b32 v66, v45, v41, s60
    v_perm_b32 v70, v45, v41, s61
    v_perm_b32 v74, v46, v42, s60
    v_perm_b32 v78, v46, v42, s61
    v_perm_b32 v82, v47, v43, s60
    v_perm_b32 v86, v47, v43, s61
    v_perm_b32 v59, v52, v48, s60
    v_perm_b32 v63, v52, v48, s61
    v_perm_b32 v67, v53, v49, s60
    v_perm_b32 v71, v53, v49, s61
    v_perm_b32 v75, v54, v50, s60
    v_perm_b32 v79, v54, v50, s61
    v_perm_b32 v83, v55, v51, s60
    v_perm_b32 v87, v55, v51, s61
    v_mfma_f32_16x16x32_bf16 v[8:11], v[88:91], v[56:59], 0
    v_mfma_f32_16x16x32_bf16 v[12:15], v[88:91], v[60:63], 0
    v_mfma_f32_16x16x32_bf16 v[8:11], v[92:95], v[64:67], v[8:11]
    v_mfma_f32_16x16x32_bf16 v[12:15], v[92:95], v[68:71], v[12:15]
    v_mfma_f32_16x16x32_bf16 v[8:11], v[96:99], v[72:75], v[8:11]
    v_mfma_f32_16x16x32_bf16 v[12:15], v[96:99], v[76:79], v[12:15]
    v_mfma_f32_16x16x32_bf16 v[8:11], v[100:103], v[80:83], v[8:11]
    v_mfma_f32_16x16x32_bf16 v[12:15], v[100:103], v[84:87], v[12:15]
    s_nop 6
    v_cndmask_b32_e64 v16, v8, v9, s[12:13]
    v_cndmask_b32_e64 v17, v12, v13, s[12:13]
    v_cndmask_b32_e64 v18, v10, v11, s[12:13]
    v_cndmask_b32_e64 v19, v14, v15, s[12:13]
    v_add_f32_dpp v16, v16, v16 row_ror:8 row_mask:0xf bank_mask:0xf
    v_add_f32_dpp v17, v17, v17 row_ror:8 row_mask:0xf bank_mask:0xf
    v_add_f32_dpp v18, v18, v18 row_ror:8 row_mask:0xf bank_mask:0xf
    v_add_f32_dpp v19, v19, v19 row_ror:8 row_mask:0xf bank_mask:0xf
    s_mov_b32 exec_lo, 0x00ff00ff
    s_mov_b32 exec_hi, 0x00ff00ff
    ds_write_b128 v22, v[16:19] offset:4352
    s_mov_b64 exec, -1
    s_waitcnt lgkmcnt(0)
    s_barrier
    s_cmp_lg_u32 s3, 0
    s_cbranch_scc1 L_t_np
    ds_read_b128 v[8:11], v23 offset:4352
    ds_read_b128 v[12:15], v23 offset:4864
    s_waitcnt lgkmcnt(0)
    v_add_f32 v8, v8, v12
    v_add_f32 v9, v9, v13
    v_add_f32 v10, v10, v14
    v_add_f32 v11, v11, v15
    s_nop 0
    v_permlane32_swap_b32 v8, v10
    v_permlane32_swap_b32 v9, v11
    v_add_f32 v8, v8, v10
    v_add_f32 v9, v9, v11
    v_min_u32 v8, -2, v8
    v_min_u32 v9, -2, v9
    s_waitcnt vmcnt(0)
    s_mov_b32 s38, 32768
    s_mov_b64 exec, 1
    s_branch L_fc_5
L_fp_3:
    buffer_load_dword v5, v123, s[52:55], 0 offen offset:128 sc1
    s_waitcnt vmcnt(0)
L_fc_5:
    v_cmp_ne_u32_e32 vcc, 1, v5
    s_cbranch_vccz L_fd_4
    s_sleep 4
    s_sub_u32 s38, s38, 1
    s_cmp_eq_u32 s38, 0
    s_cbranch_scc0 L_fp_3
L_fd_4:
    s_mov_b64 exec, -1
    buffer_store_dwordx2 v[8:9], v6, s[40:43], s8 offen sc1
L_t_np:
    s_barrier
    s_cmp_lt_u32 s5, 8
    s_cbranch_scc1 L_s3
    s_cmp_lt_u32 s5, 15
    s_cbranch_scc1 L_ffn
    s_cmp_eq_u32 s3, 1
    s_cbranch_scc1 L_touch
    s_cmp_lg_u32 s3, 0
    s_cbranch_scc1 L_exit
    s_lshl_b32 s8, s4, 13
    s_add_u32 s9, s8, 4096
    v_and_b32 v2, 15, v0
    v_lshlrev_b32 v2, 4, v2
    v_lshl_add_u32 v2, v3, 9, v2
    s_mov_b32 s38, 32768
    buffer_load_dwordx4 v[8:11], v2, s[40:43], s8 offen sc1
    buffer_load_dwordx4 v[12:15], v2, s[40:43], s8 offen offset:2048 sc1
    buffer_load_dwordx4 v[16:19], v2, s[40:43], s9 offen sc1
    buffer_load_dwordx4 v[20:23], v2, s[40:43], s9 offen offset:2048 sc1
L_pl_6:
    s_waitcnt vmcnt(0)
    v_max3_u32 v24, v8, v9, v10
    v_max_u32 v24, v24, v11
    v_cmp_eq_u32_e64 s[64:65], -1, v24
    v_max3_u32 v25, v12, v13, v14
    v_max_u32 v25, v25, v15
    v_cmp_eq_u32_e64 s[66:67], -1, v25
    v_max3_u32 v24, v16, v17, v18
    v_max_u32 v24, v24, v19
    v_cmp_eq_u32_e64 s[68:69], -1, v24
    v_max3_u32 v25, v20, v21, v22
    v_max_u32 v25, v25, v23
    v_cmp_eq_u32_e64 s[70:71], -1, v25
    s_nop 0
    s_or_b64 s[6:7], s[64:65], s[66:67]
    s_or_b64 s[6:7], s[6:7], s[68:69]
    s_or_b64 s[6:7], s[6:7], s[70:71]
    s_cmp_eq_u64 s[6:7], 0
    s_cbranch_scc1 L_pd_7
    s_sleep 2
    s_mov_b64 exec, s[64:65]
    s_cbranch_execz L_sk_8
    buffer_load_dwordx4 v[8:11], v2, s[40:43], s8 offen sc1
L_sk_8:
    s_mov_b64 exec, s[66:67]
    s_cbranch_execz L_sk_9
    buffer_load_dwordx4 v[12:15], v2, s[40:43], s8 offen offset:2048 sc1
L_sk_9:
    s_mov_b64 exec, s[68:69]
    s_cbranch_execz L_sk_10
    buffer_load_dwordx4 v[16:19], v2, s[40:43], s9 offen sc1
L_sk_10:
    s_mov_b64 exec, s[70:71]
    s_cbranch_execz L_sk_11
    buffer_load_dwordx4 v[20:23], v2, s[40:43], s9 offen offset:2048 sc1
L_sk_11:
    s_mov_b64 exec, -1
    s_sub_u32 s38, s38, 1
    s_cmp_eq_u32 s38, 0
    s_cbranch_scc0 L_pl_6
    s_waitcnt vmcnt(0)
L_pd_7:
    v_mov_b32 v4, 1
    s_mov_b64 exec, 1
    buffer_store_dword v4, v123, s[52:55], 0 offen sc1
    s_mov_b64 exec, -1
    s_branch L_exit
L_touch:
    s_getpc_b64 s[6:7]
L_pc:
    s_sub_u32 s6, s6, L_pc - sequential_preLN__sliding_block_cached__dense_activation_silu__decode_kernel
    s_subb_u32 s7, s7, 0
    global_load_dwordx4 v[12:15], v7, s[6:7] offset:0
    global_load_dwordx4 v[12:15], v7, s[6:7] offset:1024
    global_load_dwordx4 v[12:15], v7, s[6:7] offset:2048
    global_load_dwordx4 v[12:15], v7, s[6:7] offset:3072
    v_add_u32 v7, 4096, v7
    global_load_dwordx4 v[12:15], v7, s[6:7] offset:0
    global_load_dwordx4 v[12:15], v7, s[6:7] offset:1024
    global_load_dwordx4 v[12:15], v7, s[6:7] offset:2048
    global_load_dwordx4 v[12:15], v7, s[6:7] offset:3072
    v_add_u32 v7, 4096, v7
    global_load_dwordx4 v[12:15], v7, s[6:7] offset:0
    global_load_dwordx4 v[12:15], v7, s[6:7] offset:1024
    s_branch L_exit
L_att1:
    s_mov_b32 s60, 0x05040100
    s_mov_b32 s61, 0x07060302
    s_mov_b32 s40, s36
    s_and_b32 s41, s37, 0xffff
    s_mov_b32 s42, 1048576
    s_mov_b32 s43, 0x20000
    s_mov_b32 s44, s16
    s_and_b32 s45, s17, 0xffff
    s_mov_b32 s46, 2048
    s_mov_b32 s47, 0x20000
    s_mov_b32 s56, s32
    s_and_b32 s57, s33, 0xffff
    s_mov_b32 s58, 2048
    s_mov_b32 s59, 0x20000
    s_lshl_b32 s14, s5, 3
    s_add_u32 s14, s14, s4
    s_lshl_b32 s15, s14, 12
    s_add_u32 s15, s15, 425984
    s_lshl_b32 s12, s4, 13
    s_lshr_b32 s7, s5, 3
    s_lshl_b32 s7, s7, 8
    s_add_u32 s12, s12, s7
    v_lshlrev_b32 v126, 4, v2
    v_lshl_add_u32 v144, v3, 9, v126
    v_lshlrev_b32 v145, 7, v3
    v_and_b32 v126, 3, v0
    v_lshl_add_u32 v145, v126, 5, v145
    v_and_b32 v126, 12, v0
    v_add_u32 v145, v145, v126
    v_lshl_add_u32 v116, v2, 8, v116
    v_add_u32 v116, s13, v116
    v_lshl_add_u32 v117, v2, 8, v117
    v_add_u32 v117, s13, v117
    v_lshl_add_u32 v118, v2, 8, v118
    v_add_u32 v118, s13, v118
    v_lshl_add_u32 v119, v2, 8, v119
    v_add_u32 v119, s13, v119
    v_and_b32 v2, 3, v0
    v_lshlrev_b32 v2, 8, v2
    v_lshl_add_u32 v6, v3, 4, v2
    v_lshrrev_b32 v2, 2, v0
    v_and_b32 v2, 3, v2
    v_cmp_eq_u32_e64 s[80:81], 0, v2
    v_cmp_eq_u32_e64 s[82:83], 1, v2
    v_cmp_eq_u32_e64 s[84:85], 2, v2
    v_cmp_eq_u32_e64 s[86:87], 3, v2
    s_mov_b32 s10, 0x3db504f3
    s_mov_b32 s11, 0x3db504f3
    s_mov_b32 s62, 0x3fb8aa3b
    s_mov_b32 s63, 0x3fb8aa3b
    s_add_u32 s39, s12, 4096
    v_mov_b32 v12, -1
    v_mov_b32 v13, -1
    v_mov_b32 v14, -1
    v_mov_b32 v15, -1
    s_lshl_b32 s6, s3, 3
    v_lshlrev_b32 v146, 6, v0
    v_add_u32 v146, s6, v146
    s_lshl_b32 s6, s3, 13
    v_add_u32 v147, s6, v7
    v_and_b32 v148, 3, v0
    v_lshlrev_b32 v148, 8, v148
    v_and_b32 v126, 12, v0
    v_lshl_add_u32 v148, v126, 4, v148
    v_and_b32 v126, 16, v0
    v_lshl_add_u32 v148, v126, 6, v148
    v_lshrrev_b32 v126, 5, v0
    s_lshl_b32 s6, s3, 1
    v_add_u32 v126, s6, v126
    v_lshl_add_u32 v148, v126, 4, v148
    v_lshlrev_b32 v149, 6, v126
    s_lshl_b32 s6, s4, 4
    s_add_u32 s6, s6, s5
    s_lshl_b32 s6, s6, 1
    s_add_u32 s6, s6, s3
    s_lshl_b32 s6, s6, 10
    s_add_u32 s13, s6, 65536
    s_mov_b32 s16, 0x7060500
    s_mov_b32 s17, 0x7060501
    s_mov_b32 s18, 0x7060502
    s_mov_b32 s19, 0x7060503
    s_waitcnt vmcnt(6)
    ds_read_b128 v[16:19], v116 offset:0
    ds_read_b128 v[20:23], v117 offset:0
    ds_read_b128 v[24:27], v118 offset:0
    ds_read_b128 v[28:31], v119 offset:0
    ds_read_b128 v[32:35], v116 offset:4096
    ds_read_b128 v[36:39], v117 offset:4096
    ds_read_b128 v[40:43], v118 offset:4096
    ds_read_b128 v[44:47], v119 offset:4096
    s_cmp_ge_u32 s3, 0
    s_cbranch_scc1 L_a_nt
    s_waitcnt vmcnt(5)
L_a_nt:
    s_barrier
    s_cmp_lg_u32 s3, 0
    s_cbranch_scc1 L_a_nq
    s_mov_b32 s38, 32768
    s_mov_b64 exec, 1
    s_branch L_fc_14
L_fp_12:
    buffer_load_dword v125, v124, s[52:55], 0 offen offset:128 sc1
    s_waitcnt vmcnt(0)
L_fc_14:
    v_cmp_ne_u32_e32 vcc, 1, v125
    s_cbranch_vccz L_fd_13
    s_sleep 4
    s_sub_u32 s38, s38, 1
    s_cmp_eq_u32 s38, 0
    s_cbranch_scc0 L_fp_12
L_fd_13:
    s_mov_b64 exec, -1
    buffer_load_dwordx4 v[128:131], v144, s[40:43], s12 offen sc1
    buffer_load_dwordx4 v[132:135], v144, s[40:43], s12 offen offset:2048 sc1
    buffer_load_dwordx4 v[136:139], v144, s[40:43], s39 offen sc1
    buffer_load_dwordx4 v[140:143], v144, s[40:43], s39 offen offset:2048 sc1
L_a_nq:
    s_barrier
    buffer_load_dwordx4 v[72:75], v5, s[48:51], s9 offen offset:512 nt
    buffer_load_dwordx4 v[76:79], v5, s[48:51], s9 offen offset:768 nt
    s_cmp_eq_u32 s3, 0
    s_cbranch_scc1 L_a_q
    s_cmp_lg_u32 s3, 1
    s_cbranch_scc1 L_a_nc
    s_cmp_ge_u32 s5, 8
    s_cbranch_scc1 L_a_nc
    s_waitcnt vmcnt(2)
    buffer_store_dwordx4 v[12:15], v7, s[40:43], s15 offen sc1
    buffer_store_dwordx4 v[12:15], v7, s[40:43], s15 offen offset:1024 sc1
    buffer_store_dwordx4 v[12:15], v7, s[40:43], s15 offen offset:2048 sc1
    buffer_store_dwordx4 v[12:15], v7, s[40:43], s15 offen offset:3072 sc1
    v_perm_b32 v160, v52, v48, s60
    v_perm_b32 v164, v52, v48, s61
    v_perm_b32 v168, v53, v49, s60
    v_perm_b32 v172, v53, v49, s61
    v_perm_b32 v176, v54, v50, s60
    v_perm_b32 v180, v54, v50, s61
    v_perm_b32 v184, v55, v51, s60
    v_perm_b32 v188, v55, v51, s61
    v_perm_b32 v161, v60, v56, s60
    v_perm_b32 v165, v60, v56, s61
    v_perm_b32 v169, v61, v57, s60
    v_perm_b32 v173, v61, v57, s61
    v_perm_b32 v177, v62, v58, s60
    v_perm_b32 v181, v62, v58, s61
    v_perm_b32 v185, v63, v59, s60
    v_perm_b32 v189, v63, v59, s61
    v_perm_b32 v162, v68, v64, s60
    v_perm_b32 v166, v68, v64, s61
    v_perm_b32 v170, v69, v65, s60
    v_perm_b32 v174, v69, v65, s61
    v_perm_b32 v178, v70, v66, s60
    v_perm_b32 v182, v70, v66, s61
    v_perm_b32 v186, v71, v67, s60
    v_perm_b32 v190, v71, v67, s61
    s_branch L_a_nq2
L_a_nc:
    s_waitcnt vmcnt(2)
    v_perm_b32 v160, v52, v48, s60
    v_perm_b32 v164, v52, v48, s61
    v_perm_b32 v168, v53, v49, s60
    v_perm_b32 v172, v53, v49, s61
    v_perm_b32 v176, v54, v50, s60
    v_perm_b32 v180, v54, v50, s61
    v_perm_b32 v184, v55, v51, s60
    v_perm_b32 v188, v55, v51, s61
    v_perm_b32 v161, v60, v56, s60
    v_perm_b32 v165, v60, v56, s61
    v_perm_b32 v169, v61, v57, s60
    v_perm_b32 v173, v61, v57, s61
    v_perm_b32 v177, v62, v58, s60
    v_perm_b32 v181, v62, v58, s61
    v_perm_b32 v185, v63, v59, s60
    v_perm_b32 v189, v63, v59, s61
    v_perm_b32 v162, v68, v64, s60
    v_perm_b32 v166, v68, v64, s61
    v_perm_b32 v170, v69, v65, s60
    v_perm_b32 v174, v69, v65, s61
    v_perm_b32 v178, v70, v66, s60
    v_perm_b32 v182, v70, v66, s61
    v_perm_b32 v186, v71, v67, s60
    v_perm_b32 v190, v71, v67, s61
    s_branch L_a_nq2
L_a_q:
    s_waitcnt vmcnt(2)
    v_max3_u32 v126, v128, v129, v130
    v_max3_u32 v126, v126, v131, v132
    v_max3_u32 v126, v126, v133, v134
    v_max3_u32 v126, v126, v135, v136
    v_max3_u32 v126, v126, v137, v138
    v_max3_u32 v126, v126, v139, v140
    v_max3_u32 v126, v126, v141, v142
    v_max_u32 v126, v126, v143
    v_cmp_eq_u32_e32 vcc, -1, v126
    s_cbranch_vccz L_a_q1ok
    s_mov_b32 s38, 32768
    buffer_load_dwordx4 v[128:131], v144, s[40:43], s12 offen sc1
    buffer_load_dwordx4 v[132:135], v144, s[40:43], s12 offen offset:2048 sc1
    buffer_load_dwordx4 v[136:139], v144, s[40:43], s39 offen sc1
    buffer_load_dwordx4 v[140:143], v144, s[40:43], s39 offen offset:2048 sc1
L_pl_15:
    s_waitcnt vmcnt(0)
    v_max3_u32 v126, v128, v129, v130
    v_max_u32 v126, v126, v131
    v_cmp_eq_u32_e64 s[64:65], -1, v126
    v_max3_u32 v127, v132, v133, v134
    v_max_u32 v127, v127, v135
    v_cmp_eq_u32_e64 s[66:67], -1, v127
    v_max3_u32 v126, v136, v137, v138
    v_max_u32 v126, v126, v139
    v_cmp_eq_u32_e64 s[68:69], -1, v126
    v_max3_u32 v127, v140, v141, v142
    v_max_u32 v127, v127, v143
    v_cmp_eq_u32_e64 s[70:71], -1, v127
    s_nop 0
    s_or_b64 s[6:7], s[64:65], s[66:67]
    s_or_b64 s[6:7], s[6:7], s[68:69]
    s_or_b64 s[6:7], s[6:7], s[70:71]
    s_cmp_eq_u64 s[6:7], 0
    s_cbranch_scc1 L_pd_16
    s_sleep 1
    s_mov_b64 exec, s[64:65]
    s_cbranch_execz L_sk_17
    buffer_load_dwordx4 v[128:131], v144, s[40:43], s12 offen sc1
L_sk_17:
    s_mov_b64 exec, s[66:67]
    s_cbranch_execz L_sk_18
    buffer_load_dwordx4 v[132:135], v144, s[40:43], s12 offen offset:2048 sc1
L_sk_18:
    s_mov_b64 exec, s[68:69]
    s_cbranch_execz L_sk_19
    buffer_load_dwordx4 v[136:139], v144, s[40:43], s39 offen sc1
L_sk_19:
    s_mov_b64 exec, s[70:71]
    s_cbranch_execz L_sk_20
    buffer_load_dwordx4 v[140:143], v144, s[40:43], s39 offen offset:2048 sc1
L_sk_20:
    s_mov_b64 exec, -1
    s_sub_u32 s38, s38, 1
    s_cmp_eq_u32 s38, 0
    s_cbranch_scc0 L_pl_15
    s_waitcnt vmcnt(0)
L_pd_16:
L_a_q1ok:
    v_pk_add_f32 v[128:129], v[128:129], v[136:137]
    v_pk_add_f32 v[130:131], v[130:131], v[138:139]
    v_pk_add_f32 v[132:133], v[132:133], v[140:141]
    v_pk_add_f32 v[134:135], v[134:135], v[142:143]
    v_cvt_pk_bf16_f32 v136, v128, v129
    v_cvt_pk_bf16_f32 v137, v130, v131
    v_cvt_pk_bf16_f32 v138, v132, v133
    v_cvt_pk_bf16_f32 v139, v134, v135
    ds_write_b32 v145, v136 offset:0
    ds_write_b32 v145, v137 offset:16
    ds_write_b32 v145, v138 offset:512
    ds_write_b32 v145, v139 offset:528
    s_branch L_a_q3
L_a_q2ok:
    v_pk_add_f32 v[192:193], v[192:193], v[200:201]
    v_pk_add_f32 v[194:195], v[194:195], v[202:203]
    v_pk_add_f32 v[196:197], v[196:197], v[204:205]
    v_pk_add_f32 v[198:199], v[198:199], v[206:207]
    v_cvt_pk_bf16_f32 v200, v192, v193
    v_cvt_pk_bf16_f32 v201, v194, v195
    v_cvt_pk_bf16_f32 v202, v196, v197
    v_cvt_pk_bf16_f32 v203, v198, v199
    ds_write_b32 v145, v200 offset:0
    ds_write_b32 v145, v201 offset:16
    ds_write_b32 v145, v202 offset:512
    ds_write_b32 v145, v203 offset:528
L_a_q3:
    s_waitcnt lgkmcnt(0)
    s_barrier
    ds_read_b128 v[80:83], v6 offset:0
    ds_read_b128 v[84:87], v6 offset:64
    ds_read_b128 v[88:91], v6 offset:128
    ds_read_b128 v[92:95], v6 offset:192
    v_perm_b32 v160, v52, v48, s60
    v_perm_b32 v164, v52, v48, s61
    v_perm_b32 v168, v53, v49, s60
    v_perm_b32 v172, v53, v49, s61
    v_perm_b32 v176, v54, v50, s60
    v_perm_b32 v180, v54, v50, s61
    v_perm_b32 v184, v55, v51, s60
    v_perm_b32 v188, v55, v51, s61
    v_perm_b32 v161, v60, v56, s60
    v_perm_b32 v165, v60, v56, s61
    v_perm_b32 v169, v61, v57, s60
    v_perm_b32 v173, v61, v57, s61
    v_perm_b32 v177, v62, v58, s60
    v_perm_b32 v181, v62, v58, s61
    v_perm_b32 v185, v63, v59, s60
    v_perm_b32 v189, v63, v59, s61
    v_perm_b32 v162, v68, v64, s60
    v_perm_b32 v166, v68, v64, s61
    v_perm_b32 v170, v69, v65, s60
    v_perm_b32 v174, v69, v65, s61
    v_perm_b32 v178, v70, v66, s60
    v_perm_b32 v182, v70, v66, s61
    v_perm_b32 v186, v71, v67, s60
    v_perm_b32 v190, v71, v67, s61
    s_branch L_a_qk
L_a_nq2:
    s_waitcnt lgkmcnt(0)
    s_barrier
    ds_read_b128 v[80:83], v6 offset:0
    ds_read_b128 v[84:87], v6 offset:64
    ds_read_b128 v[88:91], v6 offset:128
    ds_read_b128 v[92:95], v6 offset:192
L_a_qk:
    s_waitcnt lgkmcnt(0)
    v_mfma_f32_16x16x32_bf16 v[96:99], v[16:19], v[80:83], 0
    v_mfma_f32_16x16x32_bf16 v[100:103], v[32:35], v[80:83], 0
    v_mfma_f32_16x16x32_bf16 v[96:99], v[20:23], v[84:87], v[96:99]
    v_mfma_f32_16x16x32_bf16 v[100:103], v[36:39], v[84:87], v[100:103]
    v_mfma_f32_16x16x32_bf16 v[96:99], v[24:27], v[88:91], v[96:99]
    v_mfma_f32_16x16x32_bf16 v[100:103], v[40:43], v[88:91], v[100:103]
    v_mfma_f32_16x16x32_bf16 v[96:99], v[28:31], v[92:95], v[96:99]
    v_mfma_f32_16x16x32_bf16 v[100:103], v[44:47], v[92:95], v[100:103]
    s_nop 6
    v_cvt_pk_bf16_f32 v88, v96, v97
    v_cvt_pk_bf16_f32 v89, v98, v99
    v_cvt_pk_bf16_f32 v90, v100, v101
    v_cvt_pk_bf16_f32 v91, v102, v103
    v_lshlrev_b32 v80, 16, v88
    v_and_b32 v81, 0xffff0000, v88
    v_lshlrev_b32 v82, 16, v89
    v_and_b32 v83, 0xffff0000, v89
    v_lshlrev_b32 v84, 16, v90
    v_and_b32 v85, 0xffff0000, v90
    v_lshlrev_b32 v86, 16, v91
    v_and_b32 v87, 0xffff0000, v91
    v_pk_mul_f32 v[80:81], v[80:81], s[10:11]
    v_pk_mul_f32 v[82:83], v[82:83], s[10:11]
    v_pk_mul_f32 v[84:85], v[84:85], s[10:11]
    v_pk_mul_f32 v[86:87], v[86:87], s[10:11]
    v_cvt_pk_bf16_f32 v88, v80, v81
    v_cvt_pk_bf16_f32 v89, v82, v83
    v_cvt_pk_bf16_f32 v90, v84, v85
    v_cvt_pk_bf16_f32 v91, v86, v87
    v_lshlrev_b32 v80, 16, v88
    v_and_b32 v81, 0xffff0000, v88
    v_lshlrev_b32 v82, 16, v89
    v_and_b32 v83, 0xffff0000, v89
    v_lshlrev_b32 v84, 16, v90
    v_and_b32 v85, 0xffff0000, v90
    v_lshlrev_b32 v86, 16, v91
    v_and_b32 v87, 0xffff0000, v91
    v_max3_f32 v92, v80, v81, v82
    v_max3_f32 v94, v83, v84, v85
    v_max3_f32 v92, v92, v86, v87
    v_max_f32 v92, v92, v94
    v_mov_b32 v94, v92
    s_nop 0
    s_nop 0
    v_permlane16_swap_b32 v92, v94
    v_max_f32 v92, v92, v94
    v_mov_b32 v94, v92
    s_nop 0
    s_nop 0
    v_permlane32_swap_b32 v92, v94
    v_max_f32 v92, v92, v94
    v_mul_f32 v92, s62, v92
    v_sub_f32 v96, 0, v92
    v_sub_f32 v97, 0, v92
    v_pk_fma_f32 v[80:81], v[80:81], s[62:63], v[96:97]
    v_pk_fma_f32 v[82:83], v[82:83], s[62:63], v[96:97]
    v_pk_fma_f32 v[84:85], v[84:85], s[62:63], v[96:97]
    v_pk_fma_f32 v[86:87], v[86:87], s[62:63], v[96:97]
    v_exp_f32 v80, v80
    v_exp_f32 v81, v81
    v_exp_f32 v82, v82
    v_exp_f32 v83, v83
    v_exp_f32 v84, v84
    v_exp_f32 v85, v85
    v_exp_f32 v86, v86
    v_exp_f32 v87, v87
    v_cvt_pk_bf16_f32 v104, v80, v81
    v_cvt_pk_bf16_f32 v105, v82, v83
    v_cvt_pk_bf16_f32 v106, v84, v85
    v_cvt_pk_bf16_f32 v107, v86, v87
    v_pk_add_f32 v[80:81], v[80:81], v[82:83]
    v_pk_add_f32 v[84:85], v[84:85], v[86:87]
    v_pk_add_f32 v[80:81], v[80:81], v[84:85]
    v_add_f32 v93, v80, v81
    v_cndmask_b32_e64 v108, 0, v104, s[80:81]
    v_cndmask_b32_e64 v109, 0, v105, s[80:81]
    v_cndmask_b32_e64 v110, 0, v106, s[80:81]
    v_cndmask_b32_e64 v111, 0, v107, s[80:81]
    v_cndmask_b32_e64 v112, 0, v104, s[82:83]
    v_cndmask_b32_e64 v113, 0, v105, s[82:83]
    v_cndmask_b32_e64 v114, 0, v106, s[82:83]
    v_cndmask_b32_e64 v115, 0, v107, s[82:83]
    v_cndmask_b32_e64 v116, 0, v104, s[84:85]
    v_cndmask_b32_e64 v117, 0, v105, s[84:85]
    v_cndmask_b32_e64 v118, 0, v106, s[84:85]
    v_cndmask_b32_e64 v119, 0, v107, s[84:85]
    v_cndmask_b32_e64 v120, 0, v104, s[86:87]
    v_cndmask_b32_e64 v121, 0, v105, s[86:87]
    v_cndmask_b32_e64 v122, 0, v106, s[86:87]
    v_cndmask_b32_e64 v123, 0, v107, s[86:87]
    s_waitcnt vmcnt(0)
    v_perm_b32 v163, v76, v72, s60
    v_perm_b32 v167, v76, v72, s61
    v_perm_b32 v171, v77, v73, s60
    v_perm_b32 v175, v77, v73, s61
    v_perm_b32 v179, v78, v74, s60
    v_perm_b32 v183, v78, v74, s61
    v_perm_b32 v187, v79, v75, s60
    v_perm_b32 v191, v79, v75, s61
    v_mfma_f32_16x16x32_bf16 v[8:11], v[160:163], v[108:111], 0
    v_mfma_f32_16x16x32_bf16 v[12:15], v[176:179], v[108:111], 0
    v_mfma_f32_16x16x32_bf16 v[8:11], v[164:167], v[112:115], v[8:11]
    v_mfma_f32_16x16x32_bf16 v[12:15], v[180:183], v[112:115], v[12:15]
    v_mfma_f32_16x16x32_bf16 v[8:11], v[168:171], v[116:119], v[8:11]
    v_mfma_f32_16x16x32_bf16 v[12:15], v[184:187], v[116:119], v[12:15]
    v_mfma_f32_16x16x32_bf16 v[8:11], v[172:175], v[120:123], v[8:11]
    v_mfma_f32_16x16x32_bf16 v[12:15], v[188:191], v[120:123], v[12:15]
    v_mov_b32 v94, v93
    s_nop 1
    v_permlane16_swap_b32 v93, v94
    v_add_f32 v93, v93, v94
    v_mov_b32 v94, v93
    s_nop 0
    s_nop 0
    v_permlane32_swap_b32 v93, v94
    v_add_f32 v93, v93, v94
    s_mov_b64 exec, 15
    ds_write_b64 v146, v[92:93] offset:1024
    s_mov_b64 exec, -1
    ds_write_b128 v147, v[8:11] offset:2048
    ds_write_b128 v147, v[12:15] offset:3072
    s_waitcnt lgkmcnt(0)
    s_barrier
    s_cmp_ge_u32 s3, 2
    s_cbranch_scc1 L_a_fin
    ds_read_b128 v[48:51], v149 offset:1024
    ds_read_b128 v[52:55], v149 offset:1040
    ds_read_b128 v[56:59], v149 offset:1056
    ds_read_b128 v[60:63], v149 offset:1072
    ds_read_b128 v[16:19], v148 offset:2048
    ds_read_b128 v[20:23], v148 offset:10240
    ds_read_b128 v[24:27], v148 offset:18432
    ds_read_b128 v[28:31], v148 offset:26624
    ds_read_b128 v[32:35], v148 offset:34816
    ds_read_b128 v[36:39], v148 offset:43008
    ds_read_b128 v[40:43], v148 offset:51200
    ds_read_b128 v[44:47], v148 offset:59392
    s_waitcnt lgkmcnt(8)
    v_max3_f32 v64, v48, v50, v52
    v_max3_f32 v65, v54, v56, v58
    v_max3_f32 v64, v64, v60, v62
    v_max_f32 v64, v64, v65
    v_sub_f32 v66, v48, v64
    v_sub_f32 v68, v50, v64
    v_sub_f32 v70, v52, v64
    v_sub_f32 v72, v54, v64
    v_sub_f32 v74, v56, v64
    v_sub_f32 v76, v58, v64
    v_sub_f32 v78, v60, v64
    v_sub_f32 v80, v62, v64
    v_exp_f32 v66, v66
    v_exp_f32 v68, v68
    v_exp_f32 v70, v70
    v_exp_f32 v72, v72
    v_exp_f32 v74, v74
    v_exp_f32 v76, v76
    v_exp_f32 v78, v78
    v_exp_f32 v80, v80
    v_mul_f32 v65, v66, v49
    v_mul_f32 v84, v68, v51
    v_fmac_f32 v65, v70, v53
    v_fmac_f32 v84, v72, v55
    v_fmac_f32 v65, v74, v57
    v_fmac_f32 v84, v76, v59
    v_fmac_f32 v65, v78, v61
    v_fmac_f32 v84, v80, v63
    v_add_f32 v65, v65, v84
    v_rcp_f32 v82, v65
    v_log_f32 v83, v65
    s_waitcnt lgkmcnt(0)
    v_pk_mul_f32 v[84:85], v[66:67], v[16:17] op_sel_hi:[0,1]
    v_pk_mul_f32 v[88:89], v[68:69], v[20:21] op_sel_hi:[0,1]
    v_pk_mul_f32 v[86:87], v[66:67], v[18:19] op_sel_hi:[0,1]
    v_pk_mul_f32 v[90:91], v[68:69], v[22:23] op_sel_hi:[0,1]
    v_pk_fma_f32 v[84:85], v[70:71], v[24:25], v[84:85] op_sel_hi:[0,1,1]
    v_pk_fma_f32 v[88:89], v[72:73], v[28:29], v[88:89] op_sel_hi:[0,1,1]
    v_pk_fma_f32 v[86:87], v[70:71], v[26:27], v[86:87] op_sel_hi:[0,1,1]
    v_pk_fma_f32 v[90:91], v[72:73], v[30:31], v[90:91] op_sel_hi:[0,1,1]
    v_pk_fma_f32 v[84:85], v[74:75], v[32:33], v[84:85] op_sel_hi:[0,1,1]
    v_pk_fma_f32 v[88:89], v[76:77], v[36:37], v[88:89] op_sel_hi:[0,1,1]
    v_pk_fma_f32 v[86:87], v[74:75], v[34:35], v[86:87] op_sel_hi:[0,1,1]
    v_pk_fma_f32 v[90:91], v[76:77], v[38:39], v[90:91] op_sel_hi:[0,1,1]
    v_pk_fma_f32 v[84:85], v[78:79], v[40:41], v[84:85] op_sel_hi:[0,1,1]
    v_pk_fma_f32 v[88:89], v[80:81], v[44:45], v[88:89] op_sel_hi:[0,1,1]
    v_pk_fma_f32 v[86:87], v[78:79], v[42:43], v[86:87] op_sel_hi:[0,1,1]
    v_pk_fma_f32 v[90:91], v[80:81], v[46:47], v[90:91] op_sel_hi:[0,1,1]
    v_add_f32 v83, v83, v64
    v_pk_add_f32 v[84:85], v[84:85], v[88:89]
    v_pk_add_f32 v[86:87], v[86:87], v[90:91]
    v_pk_mul_f32 v[84:85], v[82:83], v[84:85] op_sel_hi:[0,1]
    v_pk_mul_f32 v[86:87], v[82:83], v[86:87] op_sel_hi:[0,1]
    v_perm_b32 v84, v84, v83, s16
    v_perm_b32 v85, v85, v83, s17
    v_perm_b32 v86, v86, v83, s18
    v_perm_b32 v87, v87, v83, s19
    v_min_u32 v84, -2, v84
    v_min_u32 v85, -2, v85
    v_min_u32 v86, -2, v86
    v_min_u32 v87, -2, v87
    buffer_store_dwordx4 v[84:87], v7, s[40:43], s13 offen sc1
    s_branch L_exit
L_a_fin:
    s_cmp_lg_u32 s3, 2
    s_cbranch_scc1 L_exit
    s_cmp_ge_u32 s5, 8
    s_cbranch_scc1 L_exit
    s_lshr_b32 s6, s14, 4
    s_lshl_b32 s6, s6, 7
    s_and_b32 s7, s14, 3
    s_lshl_b32 s7, s7, 5
    s_add_u32 s6, s6, s7
    s_bfe_u32 s7, s14, 0x20002
    s_lshl_b32 s7, s7, 1
    s_add_u32 s6, s6, s7
    v_and_b32 v2, 3, v0
    v_lshlrev_b32 v2, 3, v2
    v_lshrrev_b32 v3, 3, v0
    v_and_b32 v3, 1, v3
    v_add3_u32 v2, v2, v3, s6
    v_and_b32 v3, 4, v0
    v_lshlrev_b32 v4, 1, v2
    v_lshl_add_u32 v4, v3, 8, v4
    buffer_load_ushort v10, v4, s[44:47], 0 offen
    v_lshrrev_b32 v5, 6, v2
    v_lshlrev_b32 v5, 9, v5
    v_lshl_add_u32 v5, v3, 6, v5
    v_and_b32 v6, 6, v2
    v_lshl_add_u32 v5, v6, 5, v5
    v_and_b32 v6, 56, v2
    v_add_u32 v5, v5, v6
    v_and_b32 v6, 1, v2
    v_lshl_add_u32 v5, v6, 2, v5
    v_lshrrev_b32 v6, 4, v0
    v_lshl_add_u32 v5, v6, 12, v5
    v_lshrrev_b32 v6, 2, v0
    v_and_b32 v6, 3, v6
    v_cmp_eq_u32_e64 s[80:81], 1, v6
    v_cmp_eq_u32_e64 s[82:83], 2, v6
    v_cmp_eq_u32_e64 s[84:85], 3, v6
    v_lshlrev_b32 v6, 2, v0
    v_mov_b32 v28, 0
    v_mov_b32 v29, 0
    v_mov_b32 v30, 0
    v_mov_b32 v31, 0
    s_mov_b32 s38, 32768
    s_mov_b64 exec, 0xff
L_fp_21:
    buffer_load_dword v8, v6, s[52:55], 0 offen sc1
    s_waitcnt vmcnt(0)
L_fc_23:
    v_cmp_ne_u32_e32 vcc, 1, v8
    s_cbranch_vccz L_fd_22
    s_sleep 4
    s_sub_u32 s38, s38, 1
    s_cmp_eq_u32 s38, 0
    s_cbranch_scc0 L_fp_21
L_fd_22:
    s_mov_b64 exec, -1
    s_mov_b32 s8, 393216
    s_mov_b32 s9, 409600
    s_mov_b32 s38, 32768
    buffer_load_dword v12, v5, s[40:43], s8 offen sc1
    buffer_load_dword v13, v5, s[40:43], s9 offen sc1
L_pl_24:
    s_waitcnt vmcnt(0)
    v_cmp_eq_u32_e64 s[64:65], -1, v12
    v_cmp_eq_u32_e64 s[66:67], -1, v13
    s_nop 0
    s_or_b64 s[6:7], s[64:65], s[66:67]
    s_cmp_eq_u64 s[6:7], 0
    s_cbranch_scc1 L_pd_25
    s_sleep 4
    s_mov_b64 exec, s[64:65]
    s_cbranch_execz L_sk_26
    buffer_load_dword v12, v5, s[40:43], s8 offen sc1
L_sk_26:
    s_mov_b64 exec, s[66:67]
    s_cbranch_execz L_sk_27
    buffer_load_dword v13, v5, s[40:43], s9 offen sc1
L_sk_27:
    s_mov_b64 exec, -1
    s_sub_u32 s38, s38, 1
    s_cmp_eq_u32 s38, 0
    s_cbranch_scc0 L_pl_24
    s_waitcnt vmcnt(0)
L_pd_25:
    v_add_f32 v12, v12, v13
    v_mov_b32 v13, v12
    s_nop 0
    s_nop 0
    v_permlane16_swap_b32 v12, v13
    v_add_f32 v12, v12, v13
    v_mov_b32 v13, v12
    s_nop 0
    s_nop 0
    v_permlane32_swap_b32 v12, v13
    v_add_f32 v12, v12, v13
    v_cvt_pk_bf16_f32 v12, v12, v12
    v_lshlrev_b32 v12, 16, v12
    v_lshlrev_b32 v10, 16, v10
    v_add_f32 v12, v12, v10
    v_cvt_pk_bf16_f32 v12, v12, v12
    v_lshlrev_b32 v12, 16, v12
    s_mov_b32 s38, 32768
    buffer_load_dwordx4 v[16:19], v7, s[40:43], s15 offen sc1
    buffer_load_dwordx4 v[20:23], v7, s[40:43], s15 offen offset:1024 sc1
    buffer_load_dwordx4 v[24:27], v7, s[40:43], s15 offen offset:2048 sc1
    s_mov_b32 exec_hi, 0
    buffer_load_dwordx4 v[28:31], v7, s[40:43], s15 offen offset:3072 sc1
    s_mov_b64 exec, -1
L_pl_28:
    s_waitcnt vmcnt(0)
    v_max3_u32 v8, v16, v17, v18
    v_max_u32 v8, v8, v19
    v_cmp_eq_u32_e64 s[64:65], -1, v8
    v_max3_u32 v9, v20, v21, v22
    v_max_u32 v9, v9, v23
    v_cmp_eq_u32_e64 s[66:67], -1, v9
    v_max3_u32 v8, v24, v25, v26
    v_max_u32 v8, v8, v27
    v_cmp_eq_u32_e64 s[68:69], -1, v8
    v_max3_u32 v9, v28, v29, v30
    v_max_u32 v9, v9, v31
    v_cmp_eq_u32_e64 s[70:71], -1, v9
    s_nop 0
    s_or_b64 s[6:7], s[64:65], s[66:67]
    s_or_b64 s[6:7], s[6:7], s[68:69]
    s_or_b64 s[6:7], s[6:7], s[70:71]
    s_cmp_eq_u64 s[6:7], 0
    s_cbranch_scc1 L_pd_29
    s_sleep 2
    s_mov_b64 exec, s[64:65]
    s_cbranch_execz L_sk_30
    buffer_load_dwordx4 v[16:19], v7, s[40:43], s15 offen sc1
L_sk_30:
    s_mov_b64 exec, s[66:67]
    s_cbranch_execz L_sk_31
    buffer_load_dwordx4 v[20:23], v7, s[40:43], s15 offen offset:1024 sc1
L_sk_31:
    s_mov_b64 exec, s[68:69]
    s_cbranch_execz L_sk_32
    buffer_load_dwordx4 v[24:27], v7, s[40:43], s15 offen offset:2048 sc1
L_sk_32:
    s_mov_b64 exec, s[70:71]
    s_cbranch_execz L_sk_33
    buffer_load_dwordx4 v[28:31], v7, s[40:43], s15 offen offset:3072 sc1
L_sk_33:
    s_mov_b64 exec, -1
    s_sub_u32 s38, s38, 1
    s_cmp_eq_u32 s38, 0
    s_cbranch_scc0 L_pl_28
    s_waitcnt vmcnt(0)
L_pd_29:
    v_pk_add_f32 v[16:17], v[16:17], v[20:21]
    v_pk_add_f32 v[24:25], v[24:25], v[28:29]
    v_pk_add_f32 v[18:19], v[18:19], v[22:23]
    v_pk_add_f32 v[26:27], v[26:27], v[30:31]
    v_pk_add_f32 v[16:17], v[16:17], v[24:25]
    v_pk_add_f32 v[18:19], v[18:19], v[26:27]
    s_nop 0
    v_add_f32_dpp v16, v16, v16 row_ror:4 row_mask:0xf bank_mask:0xf
    v_add_f32_dpp v17, v17, v17 row_ror:4 row_mask:0xf bank_mask:0xf
    v_add_f32_dpp v18, v18, v18 row_ror:4 row_mask:0xf bank_mask:0xf
    v_add_f32_dpp v19, v19, v19 row_ror:4 row_mask:0xf bank_mask:0xf
    v_add_f32_dpp v16, v16, v16 row_ror:8 row_mask:0xf bank_mask:0xf
    v_add_f32_dpp v17, v17, v17 row_ror:8 row_mask:0xf bank_mask:0xf
    v_add_f32_dpp v18, v18, v18 row_ror:8 row_mask:0xf bank_mask:0xf
    v_add_f32_dpp v19, v19, v19 row_ror:8 row_mask:0xf bank_mask:0xf
    v_cndmask_b32_e64 v16, v16, v17, s[80:81]
    v_cndmask_b32_e64 v16, v16, v18, s[82:83]
    v_cndmask_b32_e64 v16, v16, v19, s[84:85]
    v_mov_b32 v20, v16
    s_nop 0
    s_nop 0
    v_permlane16_swap_b32 v16, v20
    v_add_f32 v16, v16, v20
    v_mov_b32 v20, v16
    s_nop 0
    s_nop 0
    v_permlane32_swap_b32 v16, v20
    v_add_f32 v16, v16, v20
    v_cvt_pk_bf16_f32 v16, v16, v16
    v_lshlrev_b32 v16, 16, v16
    v_add_f32 v16, v16, v12
    v_cvt_pk_bf16_f32 v16, v16, v16
    s_mov_b64 exec, 0xffff
    buffer_store_short v16, v4, s[56:59], 0 offen
    s_mov_b64 exec, -1
    s_branch L_exit
L_s3:
    s_mov_b32 s56, s24
    s_and_b32 s57, s25, 0xffff
    s_mov_b32 s58, 4194304
    s_mov_b32 s59, 0x20000
    v_and_b32 v2, 8, v0
    v_lshl_add_u32 v2, v2, 3, v3
    v_lshlrev_b32 v2, 10, v2
    v_and_b32 v4, 7, v0
    v_lshl_add_u32 v2, v4, 4, v2
    s_lshl_b32 s6, s4, 2
    s_lshr_b32 s7, s3, 1
    s_add_u32 s6, s6, s7
    s_lshl_b32 s6, s6, 7
    s_and_b32 s7, s3, 1
    s_lshl_b32 s7, s7, 2
    s_add_u32 s6, s6, s7
    s_lshl_b32 s6, s6, 10
    s_lshl_b32 s7, s5, 7
    s_add_u32 s6, s6, s7
    buffer_load_dwordx4 v[16:19], v2, s[56:59], s6 offen nt
    s_add_u32 s6, s6, 8192
    buffer_load_dwordx4 v[20:23], v2, s[56:59], s6 offen nt
    s_add_u32 s6, s6, 8192
    buffer_load_dwordx4 v[24:27], v2, s[56:59], s6 offen nt
    s_add_u32 s6, s6, 8192
    buffer_load_dwordx4 v[28:31], v2, s[56:59], s6 offen nt
    s_add_u32 s6, s6, 8192
    buffer_load_dwordx4 v[32:35], v2, s[56:59], s6 offen nt
    s_add_u32 s6, s6, 8192
    buffer_load_dwordx4 v[36:39], v2, s[56:59], s6 offen nt
    s_add_u32 s6, s6, 8192
    buffer_load_dwordx4 v[40:43], v2, s[56:59], s6 offen nt
    s_add_u32 s6, s6, 8192
    buffer_load_dwordx4 v[44:47], v2, s[56:59], s6 offen nt
    v_lshlrev_b32 v5, 11, v3
    v_and_b32 v6, 15, v0
    v_lshl_add_u32 v8, v6, 4, v5
    s_lshl_b32 s6, s3, 8
    v_lshl_add_u32 v9, v6, 3, s6
    v_and_b32 v5, 32, v0
    v_lshl_add_u32 v9, v5, 2, v9
    v_and_b32 v5, 1, v3
    v_lshl_add_u32 v9, v5, 2, v9
    v_and_b32 v5, 1, v0
    v_lshl_add_u32 v5, v3, 1, v5
    v_lshl_add_u32 v10, v5, 4, s6
    v_and_b32 v5, 2, v0
    v_lshl_add_u32 v10, v5, 6, v10
    v_lshl_add_u32 v5, v3, 3, v4
    s_lshl_b32 s7, s3, 9
    v_lshl_add_u32 v11, v5, 4, s7
    v_and_b32 v5, 31, v0
    v_lshlrev_b32 v5, 4, v5
    v_and_b32 v6, 32, v0
    v_lshl_add_u32 v12, v6, 6, v5
    v_lshlrev_b32 v13, 3, v0
    s_lshl_b32 s7, s4, 15
    s_add_u32 s6, s6, s7
    s_add_u32 s8, s6, 65536
    s_add_u32 s9, s6, 73728
    s_add_u32 s10, s6, 81920
    s_add_u32 s11, s6, 90112
    s_lshl_b32 s6, s4, 3
    s_add_u32 s6, s6, s5
    s_lshl_b32 s12, s6, 9
    s_add_u32 s12, s12, 393216
    v_lshrrev_b32 v5, 2, v0
    v_and_b32 v5, 3, v5
    v_mov_b32 v6, 4224
    v_cmp_eq_u32_e64 vcc, 0, v5
    s_nop 1
    v_cndmask_b32_e64 v116, v6, v10, vcc
    v_cmp_eq_u32_e64 vcc, 1, v5
    s_nop 1
    v_cndmask_b32_e64 v117, v6, v10, vcc
    v_cmp_eq_u32_e64 vcc, 2, v5
    s_nop 1
    v_cndmask_b32_e64 v118, v6, v10, vcc
    v_cmp_eq_u32_e64 vcc, 3, v5
    s_nop 1
    v_cndmask_b32_e64 v119, v6, v10, vcc
    v_mov_b32 v112, 0
    v_mov_b32 v113, 0
    v_mov_b32 v114, 0
    v_mov_b32 v115, 0
    ds_write_b128 v6, v[112:115] offset:0
    v_and_b32 v5, 8, v0
    v_cmp_ne_u32_e64 s[14:15], 0, v5
    s_mov_b32 s13, 0x0c0c0400
    s_waitcnt vmcnt(0)
    v_perm_b32 v48, v20, v16, s60
    v_perm_b32 v52, v20, v16, s61
    v_perm_b32 v56, v21, v17, s60
    v_perm_b32 v60, v21, v17, s61
    v_perm_b32 v64, v22, v18, s60
    v_perm_b32 v68, v22, v18, s61
    v_perm_b32 v72, v23, v19, s60
    v_perm_b32 v76, v23, v19, s61
    v_perm_b32 v49, v28, v24, s60
    v_perm_b32 v53, v28, v24, s61
    v_perm_b32 v57, v29, v25, s60
    v_perm_b32 v61, v29, v25, s61
    v_perm_b32 v65, v30, v26, s60
    v_perm_b32 v69, v30, v26, s61
    v_perm_b32 v73, v31, v27, s60
    v_perm_b32 v77, v31, v27, s61
    v_perm_b32 v50, v36, v32, s60
    v_perm_b32 v54, v36, v32, s61
    v_perm_b32 v58, v37, v33, s60
    v_perm_b32 v62, v37, v33, s61
    v_perm_b32 v66, v38, v34, s60
    v_perm_b32 v70, v38, v34, s61
    v_perm_b32 v74, v39, v35, s60
    v_perm_b32 v78, v39, v35, s61
    v_perm_b32 v51, v44, v40, s60
    v_perm_b32 v55, v44, v40, s61
    v_perm_b32 v59, v45, v41, s60
    v_perm_b32 v63, v45, v41, s61
    v_perm_b32 v67, v46, v42, s60
    v_perm_b32 v71, v46, v42, s61
    v_perm_b32 v75, v47, v43, s60
    v_perm_b32 v79, v47, v43, s61
    s_cmp_lg_u32 s3, 0
    s_cbranch_scc1 L_s3_nf
    s_mov_b32 s38, 32768
    s_mov_b64 exec, 1
L_fp_34:
    buffer_load_dword v5, v123, s[52:55], 0 offen sc1
    s_waitcnt vmcnt(0)
L_fc_36:
    v_cmp_ne_u32_e32 vcc, 1, v5
    s_cbranch_vccz L_fd_35
    s_sleep 8
    s_sub_u32 s38, s38, 1
    s_cmp_eq_u32 s38, 0
    s_cbranch_scc0 L_fp_34
L_fd_35:
    s_mov_b64 exec, -1
L_s3_nf:
    s_barrier
    s_mov_b32 s38, 32768
    buffer_load_dwordx4 v[80:83], v8, s[40:43], s8 offen sc1
    buffer_load_dwordx4 v[84:87], v8, s[40:43], s9 offen sc1
    buffer_load_dwordx4 v[88:91], v8, s[40:43], s10 offen sc1
    buffer_load_dwordx4 v[92:95], v8, s[40:43], s11 offen sc1
L_pl_37:
    s_waitcnt vmcnt(0)
    v_max3_u32 v5, v80, v81, v82
    v_max_u32 v5, v5, v83
    v_cmp_eq_u32_e64 s[64:65], -1, v5
    v_max3_u32 v6, v84, v85, v86
    v_max_u32 v6, v6, v87
    v_cmp_eq_u32_e64 s[66:67], -1, v6
    v_max3_u32 v5, v88, v89, v90
    v_max_u32 v5, v5, v91
    v_cmp_eq_u32_e64 s[68:69], -1, v5
    v_max3_u32 v6, v92, v93, v94
    v_max_u32 v6, v6, v95
    v_cmp_eq_u32_e64 s[70:71], -1, v6
    s_nop 0
    s_or_b64 s[6:7], s[64:65], s[66:67]
    s_or_b64 s[6:7], s[6:7], s[68:69]
    s_or_b64 s[6:7], s[6:7], s[70:71]
    s_cmp_eq_u64 s[6:7], 0
    s_cbranch_scc1 L_pd_38
    s_sleep 2
    s_mov_b64 exec, s[64:65]
    s_cbranch_execz L_sk_39
    buffer_load_dwordx4 v[80:83], v8, s[40:43], s8 offen sc1
L_sk_39:
    s_mov_b64 exec, s[66:67]
    s_cbranch_execz L_sk_40
    buffer_load_dwordx4 v[84:87], v8, s[40:43], s9 offen sc1
L_sk_40:
    s_mov_b64 exec, s[68:69]
    s_cbranch_execz L_sk_41
    buffer_load_dwordx4 v[88:91], v8, s[40:43], s10 offen sc1
L_sk_41:
    s_mov_b64 exec, s[70:71]
    s_cbranch_execz L_sk_42
    buffer_load_dwordx4 v[92:95], v8, s[40:43], s11 offen sc1
L_sk_42:
    s_mov_b64 exec, -1
    s_sub_u32 s38, s38, 1
    s_cmp_eq_u32 s38, 0
    s_cbranch_scc0 L_pl_37
    s_waitcnt vmcnt(0)
L_pd_38:
    v_perm_b32 v96, v81, v80, s13
    v_perm_b32 v97, v83, v82, s13
    v_perm_b32 v98, v85, v84, s13
    v_perm_b32 v99, v87, v86, s13
    v_perm_b32 v100, v89, v88, s13
    v_perm_b32 v101, v91, v90, s13
    v_perm_b32 v102, v93, v92, s13
    v_perm_b32 v103, v95, v94, s13
    v_perm_b32 v96, v97, v96, s60
    v_perm_b32 v98, v99, v98, s60
    v_perm_b32 v100, v101, v100, s60
    v_perm_b32 v102, v103, v102, s60
    v_max_f32 v114, v96, v98
    v_max_f32 v115, v100, v102
    v_mov_b32 v97, v114
    v_mov_b32 v99, v115
    s_nop 0
    v_permlane16_swap_b32 v114, v97
    v_permlane16_swap_b32 v115, v99
    v_max_f32 v114, v114, v97
    v_max_f32 v115, v115, v99
    v_mov_b32 v97, v114
    v_mov_b32 v99, v115
    s_nop 0
    v_permlane32_swap_b32 v114, v97
    v_permlane32_swap_b32 v115, v99
    v_max_f32 v114, v114, v97
    v_max_f32 v115, v115, v99
    v_sub_f32 v96, v96, v114
    v_sub_f32 v98, v98, v114
    v_sub_f32 v100, v100, v115
    v_sub_f32 v102, v102, v115
    v_exp_f32 v96, v96
    v_exp_f32 v98, v98
    v_exp_f32 v100, v100
    v_exp_f32 v102, v102
    v_pk_mul_f32 v[104:105], v[96:97], v[80:81] op_sel_hi:[0,1]
    v_pk_mul_f32 v[106:107], v[96:97], v[82:83] op_sel_hi:[0,1]
    v_add_f32 v112, v96, v98
    v_pk_mul_f32 v[108:109], v[100:101], v[88:89] op_sel_hi:[0,1]
    v_pk_mul_f32 v[110:111], v[100:101], v[90:91] op_sel_hi:[0,1]
    v_add_f32 v113, v100, v102
    v_pk_fma_f32 v[104:105], v[98:99], v[84:85], v[104:105] op_sel_hi:[0,1,1]
    v_pk_fma_f32 v[106:107], v[98:99], v[86:87], v[106:107] op_sel_hi:[0,1,1]
    v_pk_fma_f32 v[108:109], v[102:103], v[92:93], v[108:109] op_sel_hi:[0,1,1]
    v_pk_fma_f32 v[110:111], v[102:103], v[94:95], v[110:111] op_sel_hi:[0,1,1]
    v_permlane32_swap_b32 v112, v113
    v_permlane32_swap_b32 v104, v108
    v_permlane32_swap_b32 v105, v109
    v_permlane32_swap_b32 v106, v110
    v_permlane32_swap_b32 v107, v111
    v_add_f32 v112, v112, v113
    v_pk_add_f32 v[104:105], v[104:105], v[108:109]
    v_pk_add_f32 v[106:107], v[106:107], v[110:111]
    v_mov_b32 v113, v112
    s_nop 0
    v_permlane16_swap_b32 v104, v106
    v_permlane16_swap_b32 v105, v107
    v_permlane16_swap_b32 v112, v113
    v_add_f32 v112, v112, v113
    v_pk_add_f32 v[104:105], v[104:105], v[106:107]
    v_rcp_f32 v112, v112
    s_nop 0
    v_pk_mul_f32 v[104:105], v[112:113], v[104:105] op_sel_hi:[0,1]
    v_cvt_pk_bf16_f32 v104, v104, v105
    ds_write_b32 v9, v104 offset:0
    s_waitcnt lgkmcnt(0)
    ds_read_b128 v[16:19], v116 offset:0
    ds_read_b128 v[20:23], v117 offset:0
    ds_read_b128 v[24:27], v118 offset:0
    ds_read_b128 v[28:31], v119 offset:0
    s_waitcnt lgkmcnt(3)
    v_mfma_f32_16x16x32_bf16 v[32:35], v[16:19], v[48:51], 0
    v_mfma_f32_16x16x32_bf16 v[36:39], v[16:19], v[52:55], 0
    s_waitcnt lgkmcnt(2)
    v_mfma_f32_16x16x32_bf16 v[32:35], v[20:23], v[56:59], v[32:35]
    v_mfma_f32_16x16x32_bf16 v[36:39], v[20:23], v[60:63], v[36:39]
    s_waitcnt lgkmcnt(1)
    v_mfma_f32_16x16x32_bf16 v[32:35], v[24:27], v[64:67], v[32:35]
    v_mfma_f32_16x16x32_bf16 v[36:39], v[24:27], v[68:71], v[36:39]
    s_waitcnt lgkmcnt(0)
    v_mfma_f32_16x16x32_bf16 v[32:35], v[28:31], v[72:75], v[32:35]
    v_mfma_f32_16x16x32_bf16 v[36:39], v[28:31], v[76:79], v[36:39]
    s_nop 6
    v_cndmask_b32_e64 v96, v32, v33, s[14:15]
    v_cndmask_b32_e64 v97, v36, v37, s[14:15]
    v_cndmask_b32_e64 v98, v34, v35, s[14:15]
    v_cndmask_b32_e64 v99, v38, v39, s[14:15]
    v_add_f32_dpp v96, v96, v96 row_ror:8 row_mask:0xf bank_mask:0xf
    v_add_f32_dpp v97, v97, v97 row_ror:8 row_mask:0xf bank_mask:0xf
    v_add_f32_dpp v98, v98, v98 row_ror:8 row_mask:0xf bank_mask:0xf
    v_add_f32_dpp v99, v99, v99 row_ror:8 row_mask:0xf bank_mask:0xf
    s_mov_b32 exec_lo, 0x00ff00ff
    s_mov_b32 exec_hi, 0x00ff00ff
    ds_write_b128 v11, v[96:99] offset:4352
    s_mov_b64 exec, -1
    s_waitcnt lgkmcnt(0)
    s_barrier
    s_cmp_lg_u32 s3, 2
    s_cbranch_scc1 L_exit
    ds_read_b128 v[96:99], v12 offset:4352
    ds_read_b128 v[100:103], v12 offset:4864
    ds_read_b128 v[104:107], v12 offset:5376
    ds_read_b128 v[108:111], v12 offset:5888
    s_waitcnt lgkmcnt(0)
    v_pk_add_f32 v[96:97], v[96:97], v[100:101]
    v_pk_add_f32 v[104:105], v[104:105], v[108:109]
    v_pk_add_f32 v[98:99], v[98:99], v[102:103]
    v_pk_add_f32 v[106:107], v[106:107], v[110:111]
    v_pk_add_f32 v[96:97], v[96:97], v[104:105]
    v_pk_add_f32 v[98:99], v[98:99], v[106:107]
    s_nop 0
    s_nop 0
    v_permlane32_swap_b32 v96, v98
    v_permlane32_swap_b32 v97, v99
    v_pk_add_f32 v[96:97], v[96:97], v[98:99]
    v_min_u32 v96, -2, v96
    v_min_u32 v97, -2, v97
    buffer_store_dwordx2 v[96:97], v13, s[40:43], s12 offen sc1
    s_branch L_exit
L_ffn:
    v_lshrrev_b32 v2, 3, v0
    v_and_b32 v4, 3, v0
    v_lshl_add_u32 v2, v2, 2, v4
    v_lshlrev_b32 v2, 4, v2
    v_and_b32 v5, 4, v0
    v_lshl_add_u32 v120, v5, 8, v2
    v_lshl_add_u32 v2, v3, 2, v4
    s_lshl_b32 s6, s3, 7
    v_lshl_add_u32 v121, v2, 3, s6
    v_lshl_add_u32 v121, v5, 8, v121
    s_lshl_b32 s6, s3, 8
    v_lshl_add_u32 v122, v2, 4, s6
    v_lshrrev_b32 v2, 2, v0
    v_and_b32 v2, 3, v2
    v_cmp_eq_u32_e64 s[80:81], 1, v2
    v_cmp_eq_u32_e64 s[82:83], 2, v2
    v_cmp_eq_u32_e64 s[84:85], 3, v2
    v_and_b32 v2, 8, v0
    v_cmp_ne_u32_e64 s[86:87], 0, v2
    v_and_b32 v119, 3, v0
    v_lshlrev_b32 v119, 4, v119
    v_and_b32 v2, 4, v0
    v_lshl_add_u32 v119, v2, 4, v119
    v_and_b32 v2, 8, v0
    v_lshrrev_b32 v2, 2, v2
    v_add_u32 v119, v119, v2
    v_and_b32 v2, 16, v0
    v_lshrrev_b32 v2, 1, v2
    v_add_u32 v119, v119, v2
    v_and_b32 v2, 32, v0
    v_lshrrev_b32 v2, 3, v2
    v_add_u32 v119, v119, v2
    s_mul_i32 s6, s4, 7
    s_add_u32 s6, s6, s5
    s_sub_u32 s39, s6, 8
    s_mov_b32 s56, s28
    s_and_b32 s57, s29, 0xffff
    s_mov_b32 s58, 1835008
    s_mov_b32 s59, 0x20000
    s_mov_b32 s48, s30
    s_and_b32 s49, s31, 0xffff
    s_mov_b32 s50, 1835008
    s_mov_b32 s51, 0x20000
    v_and_b32 v2, 12, v0
    v_lshlrev_b32 v2, 2, v2
    v_lshl_add_u32 v2, v3, 1, v2
    v_mul_u32_u24 v2, 3584, v2
    v_and_b32 v4, 3, v0
    v_lshl_add_u32 v2, v4, 4, v2
    s_mul_i32 s6, s3, 229376
    s_lshl_b32 s7, s39, 6
    s_add_u32 s6, s6, s7
    s_add_u32 s7, s6, 0
    buffer_load_dwordx4 v[20:23], v2, s[56:59], s7 offen nt
    s_add_u32 s7, s6, 3584
    buffer_load_dwordx4 v[24:27], v2, s[56:59], s7 offen nt
    s_add_u32 s7, s6, 28672
    buffer_load_dwordx4 v[28:31], v2, s[56:59], s7 offen nt
    s_add_u32 s7, s6, 32256
    buffer_load_dwordx4 v[32:35], v2, s[56:59], s7 offen nt
    s_cmp_ge_u32 s3, 4
    s_cbranch_scc1 L_f_n2
    v_lshlrev_b32 v2, 13, v3
    v_and_b32 v4, 15, v0
    v_lshl_add_u32 v2, v4, 4, v2
    s_lshl_b32 s6, s39, 15
    s_lshl_b32 s7, s3, 8
    s_add_u32 s6, s6, s7
    s_add_u32 s7, s6, 4096
    buffer_load_dwordx4 v[128:131], v2, s[48:51], s6 offen nt
    buffer_load_dwordx4 v[132:135], v2, s[48:51], s6 offen offset:1024 nt
    buffer_load_dwordx4 v[136:139], v2, s[48:51], s6 offen offset:2048 nt
    buffer_load_dwordx4 v[140:143], v2, s[48:51], s6 offen offset:3072 nt
    buffer_load_dwordx4 v[144:147], v2, s[48:51], s7 offen nt
    buffer_load_dwordx4 v[148:151], v2, s[48:51], s7 offen offset:1024 nt
    buffer_load_dwordx4 v[152:155], v2, s[48:51], s7 offen offset:2048 nt
    buffer_load_dwordx4 v[156:159], v2, s[48:51], s7 offen offset:3072 nt
L_f_n2:
    v_and_b32 v4, 31, v0
    v_and_b32 v5, 32, v0
    v_lshlrev_b32 v5, 7, v5
    v_lshl_add_u32 v8, v4, 4, v5
    v_and_b32 v5, 15, v0
    s_lshl_b32 s6, s3, 7
    v_lshl_add_u32 v9, v5, 3, s6
    v_and_b32 v5, 16, v0
    v_lshl_add_u32 v9, v5, 6, v9
    v_and_b32 v6, 3, v0
    v_lshl_add_u32 v6, v6, 5, s6
    v_lshl_add_u32 v6, v5, 6, v6
    v_and_b32 v5, 12, v0
    v_add_u32 v6, v6, v5
    v_and_b32 v5, 32, v0
    v_lshrrev_b32 v5, 1, v5
    v_add_u32 v6, v6, v5
    v_lshrrev_b32 v5, 2, v5
    v_add_u32 v9, v9, v5
    buffer_load_dword v10, v6, s[44:47], 0 offen
    s_lshl_b32 s6, s3, 9
    s_add_u32 s8, s6, 393216
    s_add_u32 s9, s6, 401408
    s_add_u32 s10, s6, 409600
    s_add_u32 s11, s6, 417792
    v_and_b32 v5, 1, v0
    v_lshlrev_b32 v5, 6, v5
    v_lshl_add_u32 v5, v3, 4, v5
    v_lshrrev_b32 v6, 1, v0
    v_and_b32 v6, 7, v6
    v_mov_b32 v4, 0x80
    v_cmp_eq_u32_e64 vcc, 0, v6
    s_nop 1
    v_cndmask_b32_e64 v192, v4, v5, vcc
    v_cmp_eq_u32_e64 vcc, 1, v6
    s_nop 1
    v_cndmask_b32_e64 v193, v4, v5, vcc
    v_cmp_eq_u32_e64 vcc, 2, v6
    s_nop 1
    v_cndmask_b32_e64 v194, v4, v5, vcc
    v_cmp_eq_u32_e64 vcc, 3, v6
    s_nop 1
    v_cndmask_b32_e64 v195, v4, v5, vcc
    v_cmp_eq_u32_e64 vcc, 4, v6
    s_nop 1
    v_cndmask_b32_e64 v196, v4, v5, vcc
    v_cmp_eq_u32_e64 vcc, 5, v6
    s_nop 1
    v_cndmask_b32_e64 v197, v4, v5, vcc
    v_cmp_eq_u32_e64 vcc, 6, v6
    s_nop 1
    v_cndmask_b32_e64 v198, v4, v5, vcc
    v_cmp_eq_u32_e64 vcc, 7, v6
    s_nop 1
    v_cndmask_b32_e64 v199, v4, v5, vcc
    v_mov_b32 v12, 0
    v_mov_b32 v13, 0
    v_mov_b32 v14, 0
    v_mov_b32 v15, 0
    ds_write_b128 v4, v[12:15] offset:4096
    v_and_b32 v5, 15, v0
    v_lshrrev_b32 v5, 2, v5
    v_lshl_add_u32 v5, v3, 2, v5
    v_lshlrev_b32 v5, 12, v5
    v_and_b32 v6, 3, v0
    v_lshl_add_u32 v200, v6, 4, v5
    s_lshl_b32 s12, s3, 16
    s_lshl_b32 s6, s39, 6
    s_add_u32 s12, s12, s6
    s_add_u32 s12, s12, 425984
    v_lshlrev_b32 v6, 2, v0
    s_waitcnt vmcnt(0)
    v_perm_b32 v36, v24, v20, s60
    v_perm_b32 v38, v24, v20, s61
    v_perm_b32 v37, v32, v28, s60
    v_perm_b32 v39, v32, v28, s61
    v_perm_b32 v40, v25, v21, s60
    v_perm_b32 v42, v25, v21, s61
    v_perm_b32 v41, v33, v29, s60
    v_perm_b32 v43, v33, v29, s61
    v_perm_b32 v44, v26, v22, s60
    v_perm_b32 v46, v26, v22, s61
    v_perm_b32 v45, v34, v30, s60
    v_perm_b32 v47, v34, v30, s61
    v_perm_b32 v48, v27, v23, s60
    v_perm_b32 v50, v27, v23, s61
    v_perm_b32 v49, v35, v31, s60
    v_perm_b32 v51, v35, v31, s61
    v_perm_b32 v160, v132, v128, s60
    v_perm_b32 v164, v132, v128, s61
    v_perm_b32 v168, v133, v129, s60
    v_perm_b32 v172, v133, v129, s61
    v_perm_b32 v176, v134, v130, s60
    v_perm_b32 v180, v134, v130, s61
    v_perm_b32 v184, v135, v131, s60
    v_perm_b32 v188, v135, v131, s61
    v_perm_b32 v161, v140, v136, s60
    v_perm_b32 v165, v140, v136, s61
    v_perm_b32 v169, v141, v137, s60
    v_perm_b32 v173, v141, v137, s61
    v_perm_b32 v177, v142, v138, s60
    v_perm_b32 v181, v142, v138, s61
    v_perm_b32 v185, v143, v139, s60
    v_perm_b32 v189, v143, v139, s61
    v_perm_b32 v162, v148, v144, s60
    v_perm_b32 v166, v148, v144, s61
    v_perm_b32 v170, v149, v145, s60
    v_perm_b32 v174, v149, v145, s61
    v_perm_b32 v178, v150, v146, s60
    v_perm_b32 v182, v150, v146, s61
    v_perm_b32 v186, v151, v147, s60
    v_perm_b32 v190, v151, v147, s61
    v_perm_b32 v163, v156, v152, s60
    v_perm_b32 v167, v156, v152, s61
    v_perm_b32 v171, v157, v153, s60
    v_perm_b32 v175, v157, v153, s61
    v_perm_b32 v179, v158, v154, s60
    v_perm_b32 v183, v158, v154, s61
    v_perm_b32 v187, v159, v155, s60
    v_perm_b32 v191, v159, v155, s61
    v_lshlrev_b32 v12, 16, v10
    v_and_b32 v13, 0xffff0000, v10
    v_lshlrev_b32 v6, 2, v0
    s_cmp_lg_u32 s3, 0
    s_cbranch_scc1 L_f_nf
    s_mov_b32 s38, 32768
    s_mov_b64 exec, 0xff
L_fp_43:
    buffer_load_dword v5, v6, s[52:55], 0 offen sc1
    s_waitcnt vmcnt(0)
L_fc_45:
    v_cmp_ne_u32_e32 vcc, 1, v5
    s_cbranch_vccz L_fd_44
    s_sleep 16
    s_sub_u32 s38, s38, 1
    s_cmp_eq_u32 s38, 0
    s_cbranch_scc0 L_fp_43
L_fd_44:
    s_mov_b64 exec, -1
L_f_nf:
    s_barrier
    s_mov_b32 s38, 32768
    buffer_load_dwordx4 v[96:99], v8, s[40:43], s8 offen sc1
    buffer_load_dwordx4 v[100:103], v8, s[40:43], s9 offen sc1
    buffer_load_dwordx4 v[104:107], v8, s[40:43], s10 offen sc1
    buffer_load_dwordx4 v[108:111], v8, s[40:43], s11 offen sc1
L_pl_46:
    s_waitcnt vmcnt(0)
    v_max3_u32 v4, v96, v97, v98
    v_max_u32 v4, v4, v99
    v_cmp_eq_u32_e64 s[64:65], -1, v4
    v_max3_u32 v5, v100, v101, v102
    v_max_u32 v5, v5, v103
    v_cmp_eq_u32_e64 s[66:67], -1, v5
    v_max3_u32 v4, v104, v105, v106
    v_max_u32 v4, v4, v107
    v_cmp_eq_u32_e64 s[68:69], -1, v4
    v_max3_u32 v5, v108, v109, v110
    v_max_u32 v5, v5, v111
    v_cmp_eq_u32_e64 s[70:71], -1, v5
    s_nop 0
    s_or_b64 s[6:7], s[64:65], s[66:67]
    s_or_b64 s[6:7], s[6:7], s[68:69]
    s_or_b64 s[6:7], s[6:7], s[70:71]
    s_cmp_eq_u64 s[6:7], 0
    s_cbranch_scc1 L_pd_47
    s_sleep 2
    s_mov_b64 exec, s[64:65]
    s_cbranch_execz L_sk_48
    buffer_load_dwordx4 v[96:99], v8, s[40:43], s8 offen sc1
L_sk_48:
    s_mov_b64 exec, s[66:67]
    s_cbranch_execz L_sk_49
    buffer_load_dwordx4 v[100:103], v8, s[40:43], s9 offen sc1
L_sk_49:
    s_mov_b64 exec, s[68:69]
    s_cbranch_execz L_sk_50
    buffer_load_dwordx4 v[104:107], v8, s[40:43], s10 offen sc1
L_sk_50:
    s_mov_b64 exec, s[70:71]
    s_cbranch_execz L_sk_51
    buffer_load_dwordx4 v[108:111], v8, s[40:43], s11 offen sc1
L_sk_51:
    s_mov_b64 exec, -1
    s_sub_u32 s38, s38, 1
    s_cmp_eq_u32 s38, 0
    s_cbranch_scc0 L_pl_46
    s_waitcnt vmcnt(0)
L_pd_47:
    v_pk_add_f32 v[96:97], v[96:97], v[100:101]
    v_pk_add_f32 v[98:99], v[98:99], v[102:103]
    v_pk_add_f32 v[104:105], v[104:105], v[108:109]
    v_pk_add_f32 v[106:107], v[106:107], v[110:111]
    v_pk_add_f32 v[96:97], v[96:97], v[104:105]
    v_pk_add_f32 v[98:99], v[98:99], v[106:107]
    s_nop 0
    s_nop 0
    v_permlane32_swap_b32 v96, v98
    v_permlane32_swap_b32 v97, v99
    v_pk_add_f32 v[96:97], v[96:97], v[98:99]
    v_cvt_pk_bf16_f32 v100, v96, v97
    v_lshlrev_b32 v96, 16, v100
    v_and_b32 v97, 0xffff0000, v100
    v_pk_add_f32 v[96:97], v[96:97], v[12:13]
    v_cvt_pk_bf16_f32 v100, v96, v97
    ds_write_b32 v9, v100 offset:2048
    s_waitcnt lgkmcnt(0)
    s_barrier
    ds_read_b128 v[8:11], v120 offset:2048
    ds_read_b128 v[12:15], v120 offset:2560
    ds_read_b64 v[16:17], v121 offset:2048
    s_waitcnt lgkmcnt(0)
    s_mov_b32 s6, 0x3f803f80
    v_dot2_f32_bf16 v80, v8, s6, 0
    v_dot2_f32_bf16 v82, v8, v8, 0
    v_dot2_f32_bf16 v81, v9, s6, 0
    v_dot2_f32_bf16 v83, v9, v9, 0
    v_dot2_f32_bf16 v80, v10, s6, v80
    v_dot2_f32_bf16 v82, v10, v10, v82
    v_dot2_f32_bf16 v81, v11, s6, v81
    v_dot2_f32_bf16 v83, v11, v11, v83
    v_dot2_f32_bf16 v80, v12, s6, v80
    v_dot2_f32_bf16 v82, v12, v12, v82
    v_dot2_f32_bf16 v81, v13, s6, v81
    v_dot2_f32_bf16 v83, v13, v13, v83
    v_dot2_f32_bf16 v80, v14, s6, v80
    v_dot2_f32_bf16 v82, v14, v14, v82
    v_dot2_f32_bf16 v81, v15, s6, v81
    v_dot2_f32_bf16 v83, v15, v15, v83
    s_nop 2
    v_add_f32 v80, v80, v81
    v_add_f32 v82, v82, v83
    s_nop 0
    v_add_f32_dpp v80, v80, v80 quad_perm:[1,0,3,2] row_mask:0xf bank_mask:0xf
    v_add_f32_dpp v82, v82, v82 quad_perm:[1,0,3,2] row_mask:0xf bank_mask:0xf
    s_nop 0
    v_add_f32_dpp v80, v80, v80 quad_perm:[2,3,0,1] row_mask:0xf bank_mask:0xf
    v_add_f32_dpp v82, v82, v82 quad_perm:[2,3,0,1] row_mask:0xf bank_mask:0xf
    s_nop 0
    v_add_f32_dpp v80, v80, v80 row_ror:8 row_mask:0xf bank_mask:0xf
    v_add_f32_dpp v82, v82, v82 row_ror:8 row_mask:0xf bank_mask:0xf
    v_mov_b32 v86, v80
    v_mov_b32 v87, v82
    s_nop 0
    v_permlane16_swap_b32 v80, v86
    v_permlane16_swap_b32 v82, v87
    v_add_f32 v80, v80, v86
    v_add_f32 v82, v82, v87
    v_mov_b32 v86, v80
    v_mov_b32 v87, v82
    s_nop 0
    v_permlane32_swap_b32 v80, v86
    v_permlane32_swap_b32 v82, v87
    v_add_f32 v80, v80, v86
    v_add_f32 v82, v82, v87
    v_mul_f32 v84, 0xbb000000, v80
    v_mul_f32 v86, v84, v80
    v_add_f32 v82, v82, v86
    v_cmp_nle_f32_e64 vcc, -v86, v82
    s_cbranch_vccz L_lnjoin_53
    v_lshlrev_b32 v64, 16, v8
    v_and_b32 v65, 0xffff0000, v8
    v_lshlrev_b32 v66, 16, v9
    v_and_b32 v67, 0xffff0000, v9
    v_lshlrev_b32 v68, 16, v10
    v_and_b32 v69, 0xffff0000, v10
    v_lshlrev_b32 v70, 16, v11
    v_and_b32 v71, 0xffff0000, v11
    v_lshlrev_b32 v72, 16, v12
    v_and_b32 v73, 0xffff0000, v12
    v_lshlrev_b32 v74, 16, v13
    v_and_b32 v75, 0xffff0000, v13
    v_lshlrev_b32 v76, 16, v14
    v_and_b32 v77, 0xffff0000, v14
    v_lshlrev_b32 v78, 16, v15
    v_and_b32 v79, 0xffff0000, v15
    v_pk_add_f32 v[80:81], v[64:65], v[66:67]
    v_pk_add_f32 v[82:83], v[68:69], v[70:71]
    v_pk_add_f32 v[80:81], v[80:81], v[72:73]
    v_pk_add_f32 v[82:83], v[82:83], v[74:75]
    v_pk_add_f32 v[80:81], v[80:81], v[76:77]
    v_pk_add_f32 v[82:83], v[82:83], v[78:79]
    v_pk_add_f32 v[80:81], v[80:81], v[82:83]
    v_add_f32 v80, v80, v81
    s_nop 1
    v_add_f32_dpp v80, v80, v80 quad_perm:[1,0,3,2] row_mask:0xf bank_mask:0xf
    s_nop 1
    v_add_f32_dpp v80, v80, v80 quad_perm:[2,3,0,1] row_mask:0xf bank_mask:0xf
    s_nop 1
    v_add_f32_dpp v80, v80, v80 row_ror:8 row_mask:0xf bank_mask:0xf
    v_mov_b32 v86, v80
    s_nop 0
    s_nop 0
    v_permlane16_swap_b32 v80, v86
    v_add_f32 v80, v80, v86
    v_mov_b32 v86, v80
    s_nop 0
    s_nop 0
    v_permlane32_swap_b32 v80, v86
    v_add_f32 v80, v80, v86
    v_mul_f32 v84, 0xbb000000, v80
    v_pk_add_f32 v[64:65], v[84:85], v[64:65] op_sel_hi:[0,1]
    v_pk_add_f32 v[66:67], v[84:85], v[66:67] op_sel_hi:[0,1]
    v_pk_add_f32 v[68:69], v[84:85], v[68:69] op_sel_hi:[0,1]
    v_pk_add_f32 v[70:71], v[84:85], v[70:71] op_sel_hi:[0,1]
    v_pk_add_f32 v[72:73], v[84:85], v[72:73] op_sel_hi:[0,1]
    v_pk_add_f32 v[74:75], v[84:85], v[74:75] op_sel_hi:[0,1]
    v_pk_add_f32 v[76:77], v[84:85], v[76:77] op_sel_hi:[0,1]
    v_pk_add_f32 v[78:79], v[84:85], v[78:79] op_sel_hi:[0,1]
    v_pk_mul_f32 v[82:83], v[64:65], v[64:65]
    v_pk_mul_f32 v[80:81], v[66:67], v[66:67]
    v_pk_fma_f32 v[82:83], v[68:69], v[68:69], v[82:83]
    v_pk_fma_f32 v[80:81], v[70:71], v[70:71], v[80:81]
    v_pk_fma_f32 v[82:83], v[72:73], v[72:73], v[82:83]
    v_pk_fma_f32 v[80:81], v[74:75], v[74:75], v[80:81]
    v_pk_fma_f32 v[82:83], v[76:77], v[76:77], v[82:83]
    v_pk_fma_f32 v[80:81], v[78:79], v[78:79], v[80:81]
    v_pk_add_f32 v[82:83], v[82:83], v[80:81]
    v_add_f32 v82, v82, v83
    s_nop 1
    v_add_f32_dpp v82, v82, v82 quad_perm:[1,0,3,2] row_mask:0xf bank_mask:0xf
    s_nop 1
    v_add_f32_dpp v82, v82, v82 quad_perm:[2,3,0,1] row_mask:0xf bank_mask:0xf
    s_nop 1
    v_add_f32_dpp v82, v82, v82 row_ror:8 row_mask:0xf bank_mask:0xf
    v_mov_b32 v86, v82
    s_nop 0
    s_nop 0
    v_permlane16_swap_b32 v82, v86
    v_add_f32 v82, v82, v86
    v_mov_b32 v86, v82
    s_nop 0
    s_nop 0
    v_permlane32_swap_b32 v82, v86
    v_add_f32 v82, v82, v86
L_lnjoin_53:
    s_nop 3
    v_cvt_pk_bf16_f32 v88, v84, v84
    v_lshlrev_b32 v88, 16, v88
    v_lshlrev_b32 v64, 16, v16
    v_and_b32 v65, 0xffff0000, v16
    v_lshlrev_b32 v66, 16, v17
    v_and_b32 v67, 0xffff0000, v17
    v_mul_f32 v82, 0x3b000000, v82
    v_cvt_pk_bf16_f32 v82, v82, v82
    v_lshlrev_b32 v82, 16, v82
    v_add_f32 v82, 0x3727c5ac, v82
    v_cvt_pk_bf16_f32 v82, v82, v82
    v_lshlrev_b32 v82, 16, v82
    v_sqrt_f32 v82, v82
    v_pk_add_f32 v[64:65], v[88:89], v[64:65] op_sel_hi:[0,1]
    v_pk_add_f32 v[66:67], v[88:89], v[66:67] op_sel_hi:[0,1]
    v_cvt_pk_bf16_f32 v82, v82, v82
    v_lshlrev_b32 v82, 16, v82
    v_rcp_f32 v86, v82
    v_cvt_pk_bf16_f32 v16, v64, v65
    v_cvt_pk_bf16_f32 v17, v66, v67
    v_lshlrev_b32 v64, 16, v16
    v_and_b32 v65, 0xffff0000, v16
    v_lshlrev_b32 v66, 16, v17
    v_and_b32 v67, 0xffff0000, v17
    v_pk_mul_f32 v[64:65], v[86:87], v[64:65] op_sel_hi:[0,1]
    v_pk_mul_f32 v[66:67], v[86:87], v[66:67] op_sel_hi:[0,1]
    v_cvt_pk_bf16_f32 v16, v64, v65
    v_cvt_pk_bf16_f32 v17, v66, v67
    v_cndmask_b32_e64 v80, v16, 0, s[86:87]
    v_cndmask_b32_e64 v82, 0, v16, s[86:87]
    v_cndmask_b32_e64 v81, v17, 0, s[86:87]
    v_cndmask_b32_e64 v83, 0, v17, s[86:87]
    s_nop 0
    v_mfma_f32_16x16x16_bf16 v[64:67], v[80:81], v[36:37], 0
    v_mfma_f32_16x16x16_bf16 v[68:71], v[80:81], v[40:41], 0
    v_mfma_f32_16x16x16_bf16 v[72:75], v[80:81], v[44:45], 0
    v_mfma_f32_16x16x16_bf16 v[76:79], v[80:81], v[48:49], 0
    v_mfma_f32_16x16x16_bf16 v[64:67], v[82:83], v[38:39], v[64:67]
    v_mfma_f32_16x16x16_bf16 v[68:71], v[82:83], v[42:43], v[68:71]
    v_mfma_f32_16x16x16_bf16 v[72:75], v[82:83], v[46:47], v[72:75]
    v_mfma_f32_16x16x16_bf16 v[76:79], v[82:83], v[50:51], v[76:79]
    s_nop 4
    v_cndmask_b32_e64 v84, v64, v65, s[80:81]
    v_cndmask_b32_e64 v84, v84, v66, s[82:83]
    v_cndmask_b32_e64 v84, v84, v67, s[84:85]
    v_cndmask_b32_e64 v85, v68, v69, s[80:81]
    v_cndmask_b32_e64 v85, v85, v70, s[82:83]
    v_cndmask_b32_e64 v85, v85, v71, s[84:85]
    v_cndmask_b32_e64 v86, v72, v73, s[80:81]
    v_cndmask_b32_e64 v86, v86, v74, s[82:83]
    v_cndmask_b32_e64 v86, v86, v75, s[84:85]
    v_cndmask_b32_e64 v87, v76, v77, s[80:81]
    v_cndmask_b32_e64 v87, v87, v78, s[82:83]
    v_cndmask_b32_e64 v87, v87, v79, s[84:85]
    v_add_f32_dpp v84, v84, v84 row_ror:4 row_mask:0xf bank_mask:0xf
    v_add_f32_dpp v85, v85, v85 row_ror:4 row_mask:0xf bank_mask:0xf
    v_add_f32_dpp v86, v86, v86 row_ror:4 row_mask:0xf bank_mask:0xf
    v_add_f32_dpp v87, v87, v87 row_ror:4 row_mask:0xf bank_mask:0xf
    v_add_f32_dpp v84, v84, v84 row_ror:8 row_mask:0xf bank_mask:0xf
    v_add_f32_dpp v85, v85, v85 row_ror:8 row_mask:0xf bank_mask:0xf
    v_add_f32_dpp v86, v86, v86 row_ror:8 row_mask:0xf bank_mask:0xf
    v_add_f32_dpp v87, v87, v87 row_ror:8 row_mask:0xf bank_mask:0xf
    s_mov_b32 exec_lo, 0x000f000f
    s_mov_b32 exec_hi, 0x000f000f
    ds_write_b128 v122, v[84:87] offset:4352
    s_mov_b64 exec, -1
    s_waitcnt lgkmcnt(0)
    s_barrier
    s_cmp_ge_u32 s3, 4
    s_cbranch_scc1 L_exit
    ds_read_b128 v[80:83], v7 offset:4352
    ds_read_b128 v[84:87], v7 offset:5376
    s_waitcnt lgkmcnt(0)
    v_pk_add_f32 v[80:81], v[80:81], v[84:85]
    v_pk_add_f32 v[82:83], v[82:83], v[86:87]
    s_nop 0
    v_permlane32_swap_b32 v80, v81
    v_permlane32_swap_b32 v82, v83
    v_add_f32 v80, v80, v81
    v_add_f32 v82, v82, v83
    s_nop 0
    s_nop 0
    v_permlane16_swap_b32 v80, v82
    v_add_f32 v80, v80, v82
    v_cvt_pk_bf16_f32 v80, v80, v80
    v_lshlrev_b32 v80, 16, v80
    v_mul_f32 v81, 0xbfb8aa3b, v80
    v_exp_f32 v81, v81
    s_nop 0
    v_add_f32 v81, 1.0, v81
    v_rcp_f32 v81, v81
    s_nop 0
    v_mul_f32 v80, v80, v81
    v_cvt_pk_bf16_f32 v80, v80, v80
    ds_write_b16 v119, v80 offset:4096
    s_waitcnt lgkmcnt(0)
    ds_read_b128 v[84:87], v192 offset:4096
    ds_read_b128 v[88:91], v193 offset:4096
    ds_read_b128 v[92:95], v194 offset:4096
    ds_read_b128 v[96:99], v195 offset:4096
    ds_read_b128 v[100:103], v196 offset:4096
    ds_read_b128 v[104:107], v197 offset:4096
    ds_read_b128 v[108:111], v198 offset:4096
    ds_read_b128 v[112:115], v199 offset:4096
    s_waitcnt lgkmcnt(7)
    v_mfma_f32_16x16x32_bf16 v[64:67], v[84:87], v[160:163], 0
    s_waitcnt lgkmcnt(6)
    v_mfma_f32_16x16x32_bf16 v[64:67], v[88:91], v[164:167], v[64:67]
    s_waitcnt lgkmcnt(5)
    v_mfma_f32_16x16x32_bf16 v[64:67], v[92:95], v[168:171], v[64:67]
    s_waitcnt lgkmcnt(4)
    v_mfma_f32_16x16x32_bf16 v[64:67], v[96:99], v[172:175], v[64:67]
    s_waitcnt lgkmcnt(3)
    v_mfma_f32_16x16x32_bf16 v[64:67], v[100:103], v[176:179], v[64:67]
    s_waitcnt lgkmcnt(2)
    v_mfma_f32_16x16x32_bf16 v[64:67], v[104:107], v[180:183], v[64:67]
    s_waitcnt lgkmcnt(1)
    v_mfma_f32_16x16x32_bf16 v[64:67], v[108:111], v[184:187], v[64:67]
    s_waitcnt lgkmcnt(0)
    v_mfma_f32_16x16x32_bf16 v[64:67], v[112:115], v[188:191], v[64:67]
    s_nop 7
    v_min_u32 v64, -2, v64
    v_min_u32 v65, -2, v65
    v_min_u32 v66, -2, v66
    v_min_u32 v67, -2, v67
    buffer_store_dwordx4 v[64:67], v200, s[40:43], s12 offen sc1
L_exit:
L_end:
    s_endpgm
.section .rodata,"a"
.p2align 6
.amdhsa_kernel sequential_preLN__sliding_block_cached__dense_activation_silu__decode_kernel
  .amdhsa_next_free_vgpr 208
  .amdhsa_next_free_sgpr 102
  .amdhsa_accum_offset 208
  .amdhsa_group_segment_fixed_size 0
  .amdhsa_kernarg_size 88
  .amdhsa_user_sgpr_count 2
  .amdhsa_user_sgpr_kernarg_segment_ptr 1
  .amdhsa_system_sgpr_workgroup_id_x 1
  .amdhsa_float_denorm_mode_32 3
.end_amdhsa_kernel
```
